```python
import torch

def _softmax(x, axis=-1):
    return torch.softmax(x, dim=axis)
def _gelu(x):
    return torch.nn.functional.gelu(x, approximate="tanh")
def _silu(x):
    return torch.nn.functional.silu(x)
def _sigmoid(x):
    return torch.sigmoid(x)
def _layernorm(x, axis=-1, eps=1e-5):
    m = x.mean(dim=axis, keepdim=True)
    v = x.var(dim=axis, keepdim=True, unbiased=False)
    return (x - m) / torch.sqrt(v + eps)
def _scatter_add(tgt, idx, src, axis=0):
    return tgt.clone().index_add_(axis, idx, src)
def _segment_sum(src, seg, n):
    out = torch.zeros((n,) + src.shape[1:], dtype=src.dtype)
    return out.index_add_(0, seg, src)
def _pad(x, pw):
    flat = tuple(v for pair in reversed(pw) for v in pair)
    return torch.nn.functional.pad(x, flat)

kernel_name = 'gated_mix__ssm_conv_s5__mixer_token_mlp__prompt'

def setup_inputs():

    _w = (lambda a: (lambda t: t.to(torch.bfloat16) if t.is_floating_point() else t)(torch.as_tensor(a)))
    def _A_setup():
        B, S, D = 1, 2048, 512
        P = D
        Lambda_re = -0.5 * (lambda _x: torch.exp(torch.as_tensor(_x)))((lambda *s: torch.randn(*s, dtype=torch.bfloat16) * 0.2)(P))
        Lambda_im = (lambda *s: torch.randn(*s, dtype=torch.bfloat16) * 0.4)(P) * 1.0
        B_re = (lambda *s: torch.randn(*s, dtype=torch.bfloat16) * 0.2)(P, D) * (D ** -0.5)
        B_im = (lambda *s: torch.randn(*s, dtype=torch.bfloat16) * 0.2)(P, D) * (D ** -0.5)
        C_re = (lambda *s: torch.randn(*s, dtype=torch.bfloat16) * 0.2)(D, P) * (P ** -0.5)
        C_im = (lambda *s: torch.randn(*s, dtype=torch.bfloat16) * 0.2)(D, P) * (P ** -0.5)
        log_dt = (lambda *s: torch.randn(*s, dtype=torch.bfloat16) * 0.2)(P) * 0.3 - 2.0
        Dskip = (lambda *s: torch.randn(*s, dtype=torch.bfloat16) * 0.05)(D)
        return {
            "x": _w((lambda *s: torch.randn(*s, dtype=torch.bfloat16) * 0.05)(B, S, D)),
            "Lambda_re": _w(Lambda_re),
            "Lambda_im": _w(Lambda_im),
            "B_re": _w(B_re),
            "B_im": _w(B_im),
            "C_re": _w(C_re),
            "C_im": _w(C_im),
            "log_dt": _w(log_dt),
            "Dskip": _w(Dskip),
        }
    _A_in = _A_setup()

    def _B_setup():
        B, S, D, F = 1, 2048, 512, 1376
        return {
            "x": _w((lambda *s: torch.randn(*s, dtype=torch.bfloat16) * 0.05)(B, S, D)),
            "w1": _w((lambda *s: torch.randn(*s, dtype=torch.bfloat16) * 0.2)(S, F) * (S ** -0.5)),
            "b1": _w((lambda *s: torch.randn(*s, dtype=torch.bfloat16) * 3.2)(F) * 0.02),
            "w2": _w((lambda *s: torch.randn(*s, dtype=torch.bfloat16) * 0.05)(F, S) * (F ** -0.5)),
            "b2": _w((lambda *s: torch.randn(*s, dtype=torch.bfloat16) * 0.1)(S) * 0.02),
        }
    _B_in = _B_setup()

    return {
        "A_x": _A_in["x"],
        "A_Lambda_re": _A_in["Lambda_re"],
        "A_Lambda_im": _A_in["Lambda_im"],
        "A_B_re": _A_in["B_re"],
        "A_B_im": _A_in["B_im"],
        "A_C_re": _A_in["C_re"],
        "A_C_im": _A_in["C_im"],
        "A_log_dt": _A_in["log_dt"],
        "A_Dskip": _A_in["Dskip"],
        "B_x": _B_in["x"],
        "B_w1": _B_in["w1"],
        "B_b1": _B_in["b1"],
        "B_w2": _B_in["w2"],
        "B_b2": _B_in["b2"],
        "gate_w": _w((lambda *s: torch.randn(*s, dtype=torch.bfloat16) * 0.05)(512) * 16.0),
    }

def reference(A_x, A_Lambda_re, A_Lambda_im, A_B_re, A_B_im, A_C_re, A_C_im, A_log_dt, A_Dskip, B_x, B_w1, B_b1, B_w2, B_b2, gate_w):
    def _A_ref(x, Lambda_re, Lambda_im, B_re, B_im, C_re, C_im, log_dt, Dskip):
        Bsz, L, H = x.shape
        Lam = Lambda_re + 1j * Lambda_im
        Bmat = B_re + 1j * B_im
        Cmat = C_re + 1j * C_im
        dt = torch.exp(log_dt)
        Lam_bar = torch.exp(dt * Lam)
        B_bar = ((Lam_bar - 1.0) / Lam)[:, None] * Bmat
        Bu = torch.einsum("bld,pd->blp", x + 0j, B_bar)
        h = torch.zeros_like(Bu[:, 0, :])
        hs = []
        for t in range(L):
            h = Lam_bar[None, :] * h + Bu[:, t, :]
            hs.append(h)
        hseq = torch.stack(hs, 1)
        y = 2.0 * torch.einsum("blp,dp->bld", hseq, Cmat).real + x * Dskip[None, None, :]
        return y

    def _B_ref(x, w1, b1, w2, b2):
        B, S, D = x.shape
        h = _layernorm(x, axis=-1)
        u = torch.einsum("bsd,sf->bdf", h, w1) + b1
        u = _gelu(u)
        y = torch.einsum("bdf,fs->bds", u, w2) + b2
        return (lambda x, *d: x.permute(*d))(y, 0, 2, 1)

    x = A_x
    g = _sigmoid((x * gate_w).sum(-1, keepdims=True))
    a = _A_ref(x, A_Lambda_re, A_Lambda_im, A_B_re, A_B_im, A_C_re, A_C_im, A_log_dt, A_Dskip)
    b = _B_ref(x, B_w1, B_b1, B_w2, B_b2)
    return g * a + (1 - g) * b
```

```asm
; @launch grid=(256,1,1) block=(256,1,1) lds=148736
.amdgcn_target "amdgcn-amd-amdhsa--gfx950"
.text
.globl gated_mix__ssm_conv_s5__mixer_token_mlp__prompt_kernel
.p2align 8
.type gated_mix__ssm_conv_s5__mixer_token_mlp__prompt_kernel,@function
gated_mix__ssm_conv_s5__mixer_token_mlp__prompt_kernel:
    s_cmp_ge_u32 s2, 256
    s_cbranch_scc1 K_END
    s_load_dwordx16 s[36:51], s[0:1], 0
    s_load_dwordx16 s[52:67], s[0:1], 64
    s_load_dwordx4 s[68:71], s[0:1], 128
    s_memrealtime s[84:85]
    v_and_b32 v1, 63, v0
    v_lshrrev_b32 v2, 6, v0
    s_mov_b32 s96, 8192
    v_readfirstlane_b32 s3, v2
    s_and_b32 s72, s2, 7
    s_lshr_b32 s73, s2, 3
    s_lshr_b32 s74, s73, 3
    s_and_b32 s73, s73, 7
    s_and_b32 s75, s72, 1
    s_lshl_b32 s75, s75, 3
    s_add_u32 s73, s73, s75
    s_lshr_b32 s72, s72, 1
    s_lshl_b32 s72, s72, 2
    s_add_u32 s72, s72, s74
    s_lshl_b32 s74, s72, 7
    s_lshl_b32 s75, s73, 5
    s_lshl_b32 s76, s73, 3
    s_add_u32 s76, s76, s74
    s_lshl_b32 s77, s3, 1
    s_add_u32 s76, s76, s77
    s_lshl_b32 s77, s76, 10
    v_lshlrev_b32 v2, 4, v1
    v_and_b32 v3, 31, v1
    v_add_u32 v14, s75, v3
    v_lshlrev_b32 v248, 3, v14
    v_lshlrev_b32 v14, 1, v14
    v_lshrrev_b32 v4, 3, v1
    v_lshrrev_b32 v5, 4, v1
    v_and_b32 v6, 7, v1
    s_lshl_b32 s78, s3, 5
    s_add_u32 s78, s78, s74
    v_add_u32 v7, 0, v5
    v_and_b32 v7, 7, v7
    v_xor_b32 v7, v7, v6
    v_lshlrev_b32 v7, 4, v7
    v_add_u32 v8, s78, v4
    v_add_u32 v8, 0, v8
    v_lshlrev_b32 v8, 10, v8
    v_add_u32 v8, v8, v7
    v_add_u32 v7, 4, v5
    v_and_b32 v7, 7, v7
    v_xor_b32 v7, v7, v6
    v_lshlrev_b32 v7, 4, v7
    v_add_u32 v9, s78, v4
    v_add_u32 v9, 7, v9
    v_lshlrev_b32 v9, 10, v9
    v_add_u32 v9, v9, v7
    v_add_u32 v7, 8, v5
    v_and_b32 v7, 7, v7
    v_xor_b32 v7, v7, v6
    v_lshlrev_b32 v7, 4, v7
    v_add_u32 v10, s78, v4
    v_add_u32 v10, 14, v10
    v_lshlrev_b32 v10, 10, v10
    v_add_u32 v10, v10, v7
    v_add_u32 v7, 12, v5
    v_and_b32 v7, 7, v7
    v_xor_b32 v7, v7, v6
    v_lshlrev_b32 v7, 4, v7
    v_add_u32 v11, s78, v4
    v_add_u32 v11, 21, v11
    v_lshlrev_b32 v11, 10, v11
    v_add_u32 v11, v11, v7
    s_and_b32 s79, s3, 1
    s_lshl_b32 s79, s79, 4
    s_add_u32 s79, s79, s75
    v_add_u32 v7, 0, v5
    v_and_b32 v7, 7, v7
    v_xor_b32 v7, v7, v6
    v_lshlrev_b32 v7, 4, v7
    v_add_u32 v12, s79, v4
    v_add_u32 v12, 0, v12
    v_lshlrev_b32 v12, 10, v12
    v_add_u32 v12, v12, v7
    v_add_u32 v7, 4, v5
    v_and_b32 v7, 7, v7
    v_xor_b32 v7, v7, v6
    v_lshlrev_b32 v7, 4, v7
    v_add_u32 v13, s79, v4
    v_add_u32 v13, 7, v13
    v_lshlrev_b32 v13, 10, v13
    v_add_u32 v13, v13, v7
    s_lshl_b32 s80, s3, 12
    s_lshl_b32 s81, s3, 11
    s_add_u32 s81, s81, 16384
    v_lshlrev_b32 v242, 11, v4
    v_lshl_add_u32 v242, v6, 4, v242
    v_lshrrev_b32 v7, 5, v1
    v_lshlrev_b32 v233, 2, v7
    v_xor_b32 v233, v233, v6
    v_lshlrev_b32 v233, 4, v233
    v_lshl_add_u32 v233, v4, 7, v233
    s_add_u32 s82, s80, 131072
    v_add_u32 v233, s82, v233
    v_lshlrev_b32 v232, 6, v7
    v_lshl_add_u32 v232, v3, 1, v232
    v_lshl_add_u32 v232, v7, 9, v232
    v_add_u32 v232, s82, v232
    v_xor_b32 v249, 64, v232
    v_lshlrev_b32 v243, 10, v1
    v_lshlrev_b32 v246, 2, v1
    s_mov_b32 s97, s72
    s_lshl_b32 s98, s78, 11
    s_lshl_b32 s99, s73, 7
    s_add_u32 s98, s98, s99
    s_add_u32 s98, s98, 16777216
    s_lshl_b32 s99, s72, 7
    s_lshl_b32 s100, s73, 2
    s_add_u32 s99, s99, s100
    s_add_u32 s99, s99, 13647872
    s_lshl_b32 s89, s72, 6
    s_add_u32 s89, s89, s100
    s_add_u32 s89, s89, 13631488
    s_lshl_b32 s88, s73, 10
    s_lshl_b32 s100, s3, 8
    s_add_u32 s88, s88, s100
    s_add_u32 s88, s88, 13631488
    v_lshrrev_b32 v4, 5, v1
    v_lshrrev_b32 v5, 1, v3
    v_and_b32 v5, 7, v5
    v_xor_b32 v5, v5, v4
    v_lshlrev_b32 v5, 4, v5
    v_lshl_add_u32 v5, v3, 7, v5
    v_xor_b32 v28, 0, v5
    v_add_u32 v16, s80, v28
    v_add_u32 v32, 49152, v28
    v_add_u32 v20, 49152, v16
    v_add_u32 v36, 98304, v28
    v_add_u32 v24, 98304, v16
    v_xor_b32 v29, 32, v5
    v_add_u32 v17, s80, v29
    v_add_u32 v33, 49152, v29
    v_add_u32 v21, 49152, v17
    v_add_u32 v37, 98304, v29
    v_add_u32 v25, 98304, v17
    v_xor_b32 v30, 64, v5
    v_add_u32 v18, s80, v30
    v_add_u32 v34, 49152, v30
    v_add_u32 v22, 49152, v18
    v_add_u32 v38, 98304, v30
    v_add_u32 v26, 98304, v18
    v_xor_b32 v31, 96, v5
    v_add_u32 v19, s80, v31
    v_add_u32 v35, 49152, v31
    v_add_u32 v23, 49152, v19
    v_add_u32 v39, 98304, v31
    v_add_u32 v27, 98304, v19
    s_waitcnt lgkmcnt(0)
    s_mov_b32 s54, s89
    s_mov_b32 s55, s88
    s_mov_b32 s4, s36
    s_and_b32 s5, s37, 0xffff
    s_mov_b32 s6, 0x200000
    s_mov_b32 s7, 0x00020000
    s_cmp_ge_u32 s3, 2
    s_cselect_b32 s8, s44, s42
    s_cselect_b32 s9, s45, s43
    s_and_b32 s9, s9, 0xffff
    s_mov_b32 s10, 0x80000
    s_mov_b32 s11, 0x00020000
    s_mov_b32 s32, s64
    s_and_b32 s33, s65, 0xffff
    s_mov_b32 s34, 0x400
    s_mov_b32 s35, 0x00020000
    s_mov_b32 s16, s70
    s_and_b32 s17, s71, 0xffff
    s_mov_b32 s18, 0x1800000
    s_mov_b32 s19, 0x00020000
    s_mov_b32 s12, s68
    s_and_b32 s13, s69, 0xffff
    s_mov_b32 s14, 0x100
    s_mov_b32 s15, 0x00020000
    s_or_b32 s83, s2, s3
    s_cmp_lg_u32 s83, 0
    s_cbranch_scc1 P1_NOZ
    s_or_b32 s84, s84, 1
    v_mov_b32 v6, s84
    s_mov_b64 exec, 1
    buffer_store_dword v6, off, s[12:15], 0 sc1
    s_mov_b64 exec, -1
P1_NOZ:
    buffer_load_dwordx4 v[168:171], v2, s[4:7], s77 offen
    buffer_load_dwordx4 v[172:175], v2, s[4:7], s77 offen offset:1024
    buffer_load_dwordx4 v[176:179], v2, s[32:35], 0 offen
    s_mov_b32 s82, 0
    s_add_u32 m0, s80, 0
    s_nop 0
    buffer_load_dwordx4 v8, s[4:7], s82 offen offset:0 lds
    buffer_load_dwordx4 v9, s[4:7], s82 offen offset:1024 lds
    buffer_load_dwordx4 v10, s[4:7], s82 offen offset:2048 lds
    buffer_load_dwordx4 v11, s[4:7], s82 offen offset:3072 lds
    s_add_u32 m0, s81, 0
    s_nop 0
    buffer_load_dwordx4 v12, s[8:11], s82 offen offset:0 lds
    buffer_load_dwordx4 v13, s[8:11], s82 offen offset:1024 lds
    s_mov_b32 s82, 128
    s_add_u32 m0, s80, 24576
    s_nop 0
    buffer_load_dwordx4 v8, s[4:7], s82 offen offset:0 lds
    buffer_load_dwordx4 v9, s[4:7], s82 offen offset:1024 lds
    buffer_load_dwordx4 v10, s[4:7], s82 offen offset:2048 lds
    buffer_load_dwordx4 v11, s[4:7], s82 offen offset:3072 lds
    s_add_u32 m0, s81, 24576
    s_nop 0
    buffer_load_dwordx4 v12, s[8:11], s82 offen offset:0 lds
    buffer_load_dwordx4 v13, s[8:11], s82 offen offset:1024 lds
    s_mov_b32 s82, 256
    s_add_u32 m0, s80, 49152
    s_nop 0
    buffer_load_dwordx4 v8, s[4:7], s82 offen offset:0 lds
    buffer_load_dwordx4 v9, s[4:7], s82 offen offset:1024 lds
    buffer_load_dwordx4 v10, s[4:7], s82 offen offset:2048 lds
    buffer_load_dwordx4 v11, s[4:7], s82 offen offset:3072 lds
    s_add_u32 m0, s81, 49152
    s_nop 0
    buffer_load_dwordx4 v12, s[8:11], s82 offen offset:0 lds
    buffer_load_dwordx4 v13, s[8:11], s82 offen offset:1024 lds
    s_waitcnt vmcnt(18)
    v_lshlrev_b32 v100, 16, v168
    v_and_b32 v101, 0xffff0000, v168
    v_lshlrev_b32 v102, 16, v169
    v_and_b32 v103, 0xffff0000, v169
    v_lshlrev_b32 v104, 16, v170
    v_and_b32 v105, 0xffff0000, v170
    v_lshlrev_b32 v106, 16, v171
    v_and_b32 v107, 0xffff0000, v171
    v_lshlrev_b32 v110, 16, v172
    v_and_b32 v111, 0xffff0000, v172
    v_lshlrev_b32 v112, 16, v173
    v_and_b32 v113, 0xffff0000, v173
    v_lshlrev_b32 v114, 16, v174
    v_and_b32 v115, 0xffff0000, v174
    v_lshlrev_b32 v116, 16, v175
    v_and_b32 v117, 0xffff0000, v175
    v_lshlrev_b32 v120, 16, v176
    v_and_b32 v121, 0xffff0000, v176
    v_lshlrev_b32 v122, 16, v177
    v_and_b32 v123, 0xffff0000, v177
    v_lshlrev_b32 v124, 16, v178
    v_and_b32 v125, 0xffff0000, v178
    v_lshlrev_b32 v126, 16, v179
    v_and_b32 v127, 0xffff0000, v179
    v_add_f32 v130, v100, v101
    v_add_f32 v130, v130, v102
    v_add_f32 v130, v130, v103
    v_add_f32 v130, v130, v104
    v_add_f32 v130, v130, v105
    v_add_f32 v130, v130, v106
    v_add_f32 v130, v130, v107
    v_mul_f32 v134, v100, v120
    v_mul_f32 v135, v101, v121
    v_mul_f32 v136, v102, v122
    v_mul_f32 v137, v103, v123
    v_mul_f32 v138, v104, v124
    v_mul_f32 v139, v105, v125
    v_mul_f32 v140, v106, v126
    v_mul_f32 v141, v107, v127
    v_cvt_pk_bf16_f32 v142, v134, v135
    v_lshlrev_b32 v134, 16, v142
    v_and_b32 v135, 0xffff0000, v142
    v_cvt_pk_bf16_f32 v142, v136, v137
    v_lshlrev_b32 v136, 16, v142
    v_and_b32 v137, 0xffff0000, v142
    v_cvt_pk_bf16_f32 v142, v138, v139
    v_lshlrev_b32 v138, 16, v142
    v_and_b32 v139, 0xffff0000, v142
    v_cvt_pk_bf16_f32 v142, v140, v141
    v_lshlrev_b32 v140, 16, v142
    v_and_b32 v141, 0xffff0000, v142
    v_add_f32 v132, v134, v135
    v_add_f32 v132, v132, v136
    v_add_f32 v132, v132, v137
    v_add_f32 v132, v132, v138
    v_add_f32 v132, v132, v139
    v_add_f32 v132, v132, v140
    v_add_f32 v132, v132, v141
    v_add_f32 v131, v110, v111
    v_add_f32 v131, v131, v112
    v_add_f32 v131, v131, v113
    v_add_f32 v131, v131, v114
    v_add_f32 v131, v131, v115
    v_add_f32 v131, v131, v116
    v_add_f32 v131, v131, v117
    v_mul_f32 v134, v110, v120
    v_mul_f32 v135, v111, v121
    v_mul_f32 v136, v112, v122
    v_mul_f32 v137, v113, v123
    v_mul_f32 v138, v114, v124
    v_mul_f32 v139, v115, v125
    v_mul_f32 v140, v116, v126
    v_mul_f32 v141, v117, v127
    v_cvt_pk_bf16_f32 v142, v134, v135
    v_lshlrev_b32 v134, 16, v142
    v_and_b32 v135, 0xffff0000, v142
    v_cvt_pk_bf16_f32 v142, v136, v137
    v_lshlrev_b32 v136, 16, v142
    v_and_b32 v137, 0xffff0000, v142
    v_cvt_pk_bf16_f32 v142, v138, v139
    v_lshlrev_b32 v138, 16, v142
    v_and_b32 v139, 0xffff0000, v142
    v_cvt_pk_bf16_f32 v142, v140, v141
    v_lshlrev_b32 v140, 16, v142
    v_and_b32 v141, 0xffff0000, v142
    v_add_f32 v133, v134, v135
    v_add_f32 v133, v133, v136
    v_add_f32 v133, v133, v137
    v_add_f32 v133, v133, v138
    v_add_f32 v133, v133, v139
    v_add_f32 v133, v133, v140
    v_add_f32 v133, v133, v141
    s_nop 1
    v_add_f32_dpp v130, v130, v130 quad_perm:[1,0,3,2] row_mask:0xf bank_mask:0xf
    v_add_f32_dpp v131, v131, v131 quad_perm:[1,0,3,2] row_mask:0xf bank_mask:0xf
    v_add_f32_dpp v132, v132, v132 quad_perm:[1,0,3,2] row_mask:0xf bank_mask:0xf
    v_add_f32_dpp v133, v133, v133 quad_perm:[1,0,3,2] row_mask:0xf bank_mask:0xf
    s_nop 1
    v_add_f32_dpp v130, v130, v130 quad_perm:[2,3,0,1] row_mask:0xf bank_mask:0xf
    v_add_f32_dpp v131, v131, v131 quad_perm:[2,3,0,1] row_mask:0xf bank_mask:0xf
    v_add_f32_dpp v132, v132, v132 quad_perm:[2,3,0,1] row_mask:0xf bank_mask:0xf
    v_add_f32_dpp v133, v133, v133 quad_perm:[2,3,0,1] row_mask:0xf bank_mask:0xf
    s_nop 1
    v_add_f32_dpp v130, v130, v130 row_half_mirror row_mask:0xf bank_mask:0xf
    v_add_f32_dpp v131, v131, v131 row_half_mirror row_mask:0xf bank_mask:0xf
    v_add_f32_dpp v132, v132, v132 row_half_mirror row_mask:0xf bank_mask:0xf
    v_add_f32_dpp v133, v133, v133 row_half_mirror row_mask:0xf bank_mask:0xf
    s_nop 1
    v_add_f32_dpp v130, v130, v130 row_mirror row_mask:0xf bank_mask:0xf
    v_add_f32_dpp v131, v131, v131 row_mirror row_mask:0xf bank_mask:0xf
    v_add_f32_dpp v132, v132, v132 row_mirror row_mask:0xf bank_mask:0xf
    v_add_f32_dpp v133, v133, v133 row_mirror row_mask:0xf bank_mask:0xf
    s_nop 1
    v_add_f32_dpp v130, v130, v130 row_bcast:15 row_mask:0xa bank_mask:0xf
    v_add_f32_dpp v131, v131, v131 row_bcast:15 row_mask:0xa bank_mask:0xf
    v_add_f32_dpp v132, v132, v132 row_bcast:15 row_mask:0xa bank_mask:0xf
    v_add_f32_dpp v133, v133, v133 row_bcast:15 row_mask:0xa bank_mask:0xf
    s_nop 1
    v_add_f32_dpp v130, v130, v130 row_bcast:31 row_mask:0xc bank_mask:0xf
    v_add_f32_dpp v131, v131, v131 row_bcast:31 row_mask:0xc bank_mask:0xf
    v_add_f32_dpp v132, v132, v132 row_bcast:31 row_mask:0xc bank_mask:0xf
    v_add_f32_dpp v133, v133, v133 row_bcast:31 row_mask:0xc bank_mask:0xf
    s_nop 0
    v_readlane_b32 s84, v130, 63
    v_readlane_b32 s85, v131, 63
    v_readlane_b32 s86, v132, 63
    v_readlane_b32 s87, v133, 63
    s_nop 1
    s_mov_b32 s82, 384
    s_add_u32 m0, s80, 73728
    s_nop 0
    buffer_load_dwordx4 v8, s[4:7], s82 offen offset:0 lds
    buffer_load_dwordx4 v9, s[4:7], s82 offen offset:1024 lds
    buffer_load_dwordx4 v10, s[4:7], s82 offen offset:2048 lds
    buffer_load_dwordx4 v11, s[4:7], s82 offen offset:3072 lds
    s_add_u32 m0, s81, 73728
    s_nop 0
    buffer_load_dwordx4 v12, s[8:11], s82 offen offset:0 lds
    buffer_load_dwordx4 v13, s[8:11], s82 offen offset:1024 lds
    v_mov_b32 v140, 0x3b000000
    v_mul_f32 v140, s84, v140
    v_sub_f32 v134, v100, v140
    v_mul_f32 v142, v134, v134
    v_sub_f32 v134, v101, v140
    v_fmac_f32 v142, v134, v134
    v_sub_f32 v134, v102, v140
    v_fmac_f32 v142, v134, v134
    v_sub_f32 v134, v103, v140
    v_fmac_f32 v142, v134, v134
    v_sub_f32 v134, v104, v140
    v_fmac_f32 v142, v134, v134
    v_sub_f32 v134, v105, v140
    v_fmac_f32 v142, v134, v134
    v_sub_f32 v134, v106, v140
    v_fmac_f32 v142, v134, v134
    v_sub_f32 v134, v107, v140
    v_fmac_f32 v142, v134, v134
    v_mov_b32 v141, 0x3b000000
    v_mul_f32 v141, s85, v141
    v_sub_f32 v134, v110, v141
    v_mul_f32 v143, v134, v134
    v_sub_f32 v134, v111, v141
    v_fmac_f32 v143, v134, v134
    v_sub_f32 v134, v112, v141
    v_fmac_f32 v143, v134, v134
    v_sub_f32 v134, v113, v141
    v_fmac_f32 v143, v134, v134
    v_sub_f32 v134, v114, v141
    v_fmac_f32 v143, v134, v134
    v_sub_f32 v134, v115, v141
    v_fmac_f32 v143, v134, v134
    v_sub_f32 v134, v116, v141
    v_fmac_f32 v143, v134, v134
    v_sub_f32 v134, v117, v141
    v_fmac_f32 v143, v134, v134
    s_nop 1
    v_add_f32_dpp v142, v142, v142 quad_perm:[1,0,3,2] row_mask:0xf bank_mask:0xf
    v_add_f32_dpp v143, v143, v143 quad_perm:[1,0,3,2] row_mask:0xf bank_mask:0xf
    s_nop 1
    v_add_f32_dpp v142, v142, v142 quad_perm:[2,3,0,1] row_mask:0xf bank_mask:0xf
    v_add_f32_dpp v143, v143, v143 quad_perm:[2,3,0,1] row_mask:0xf bank_mask:0xf
    s_nop 1
    v_add_f32_dpp v142, v142, v142 row_half_mirror row_mask:0xf bank_mask:0xf
    v_add_f32_dpp v143, v143, v143 row_half_mirror row_mask:0xf bank_mask:0xf
    s_nop 1
    v_add_f32_dpp v142, v142, v142 row_mirror row_mask:0xf bank_mask:0xf
    v_add_f32_dpp v143, v143, v143 row_mirror row_mask:0xf bank_mask:0xf
    s_nop 1
    v_add_f32_dpp v142, v142, v142 row_bcast:15 row_mask:0xa bank_mask:0xf
    v_add_f32_dpp v143, v143, v143 row_bcast:15 row_mask:0xa bank_mask:0xf
    s_nop 1
    v_add_f32_dpp v142, v142, v142 row_bcast:31 row_mask:0xc bank_mask:0xf
    v_add_f32_dpp v143, v143, v143 row_bcast:31 row_mask:0xc bank_mask:0xf
    s_nop 0
    v_readlane_b32 s88, v142, 63
    v_readlane_b32 s89, v143, 63
    s_nop 1
    s_mov_b32 s82, 512
    s_add_u32 m0, s80, 98304
    s_nop 0
    buffer_load_dwordx4 v8, s[4:7], s82 offen offset:0 lds
    buffer_load_dwordx4 v9, s[4:7], s82 offen offset:1024 lds
    buffer_load_dwordx4 v10, s[4:7], s82 offen offset:2048 lds
    buffer_load_dwordx4 v11, s[4:7], s82 offen offset:3072 lds
    s_add_u32 m0, s81, 98304
    s_nop 0
    buffer_load_dwordx4 v12, s[8:11], s82 offen offset:0 lds
    buffer_load_dwordx4 v13, s[8:11], s82 offen offset:1024 lds
    v_mov_b32 v144, 0x3b000000
    v_mul_f32 v144, s88, v144
    v_cvt_pk_bf16_f32 v134, v144, v144
    v_lshlrev_b32 v144, 16, v134
    v_add_f32 v144, 0x3727c5ac, v144
    v_cvt_pk_bf16_f32 v134, v144, v144
    v_lshlrev_b32 v144, 16, v134
    v_sqrt_f32 v144, v144
    s_nop 0
    v_cvt_pk_bf16_f32 v134, v144, v144
    v_lshlrev_b32 v144, 16, v134
    v_rcp_f32 v145, v144
    v_cvt_pk_bf16_f32 v134, v140, v140
    v_lshlrev_b32 v140, 16, v134
    v_sub_f32 v100, v100, v140
    v_sub_f32 v101, v101, v140
    v_sub_f32 v102, v102, v140
    v_sub_f32 v103, v103, v140
    v_sub_f32 v104, v104, v140
    v_sub_f32 v105, v105, v140
    v_sub_f32 v106, v106, v140
    v_sub_f32 v107, v107, v140
    v_cvt_pk_bf16_f32 v134, v100, v101
    v_lshlrev_b32 v100, 16, v134
    v_and_b32 v101, 0xffff0000, v134
    v_cvt_pk_bf16_f32 v134, v102, v103
    v_lshlrev_b32 v102, 16, v134
    v_and_b32 v103, 0xffff0000, v134
    v_cvt_pk_bf16_f32 v134, v104, v105
    v_lshlrev_b32 v104, 16, v134
    v_and_b32 v105, 0xffff0000, v134
    v_cvt_pk_bf16_f32 v134, v106, v107
    v_lshlrev_b32 v106, 16, v134
    v_and_b32 v107, 0xffff0000, v134
    v_mul_f32 v146, v100, v145
    v_fma_f32 v147, -v146, v144, v100
    v_fma_f32 v100, v147, v145, v146
    v_mul_f32 v146, v101, v145
    v_fma_f32 v147, -v146, v144, v101
    v_fma_f32 v101, v147, v145, v146
    v_mul_f32 v146, v102, v145
    v_fma_f32 v147, -v146, v144, v102
    v_fma_f32 v102, v147, v145, v146
    v_mul_f32 v146, v103, v145
    v_fma_f32 v147, -v146, v144, v103
    v_fma_f32 v103, v147, v145, v146
    v_mul_f32 v146, v104, v145
    v_fma_f32 v147, -v146, v144, v104
    v_fma_f32 v104, v147, v145, v146
    v_mul_f32 v146, v105, v145
    v_fma_f32 v147, -v146, v144, v105
    v_fma_f32 v105, v147, v145, v146
    v_mul_f32 v146, v106, v145
    v_fma_f32 v147, -v146, v144, v106
    v_fma_f32 v106, v147, v145, v146
    v_mul_f32 v146, v107, v145
    v_fma_f32 v147, -v146, v144, v107
    v_fma_f32 v107, v147, v145, v146
    v_cvt_pk_bf16_f32 v150, v100, v101
    v_cvt_pk_bf16_f32 v151, v102, v103
    v_cvt_pk_bf16_f32 v152, v104, v105
    v_cvt_pk_bf16_f32 v153, v106, v107
    v_mov_b32 v132, s86
    v_cvt_pk_bf16_f32 v134, v132, v132
    v_lshlrev_b32 v132, 16, v134
    v_mul_f32 v132, 0xbfb8aa3b, v132
    v_exp_f32 v132, v132
    s_nop 0
    v_add_f32 v132, 1.0, v132
    v_rcp_f32 v132, v132
    s_nop 0
    v_cvt_pk_bf16_f32 v134, v132, v132
    v_lshlrev_b32 v132, 16, v134
    s_mov_b32 s82, 640
    s_add_u32 m0, s80, 122880
    s_nop 0
    buffer_load_dwordx4 v8, s[4:7], s82 offen offset:0 lds
    buffer_load_dwordx4 v9, s[4:7], s82 offen offset:1024 lds
    buffer_load_dwordx4 v10, s[4:7], s82 offen offset:2048 lds
    buffer_load_dwordx4 v11, s[4:7], s82 offen offset:3072 lds
    s_add_u32 m0, s81, 122880
    s_nop 0
    buffer_load_dwordx4 v12, s[8:11], s82 offen offset:0 lds
    buffer_load_dwordx4 v13, s[8:11], s82 offen offset:1024 lds
    v_mov_b32 v144, 0x3b000000
    v_mul_f32 v144, s89, v144
    v_cvt_pk_bf16_f32 v134, v144, v144
    v_lshlrev_b32 v144, 16, v134
    v_add_f32 v144, 0x3727c5ac, v144
    v_cvt_pk_bf16_f32 v134, v144, v144
    v_lshlrev_b32 v144, 16, v134
    v_sqrt_f32 v144, v144
    s_nop 0
    v_cvt_pk_bf16_f32 v134, v144, v144
    v_lshlrev_b32 v144, 16, v134
    v_rcp_f32 v145, v144
    v_cvt_pk_bf16_f32 v134, v141, v141
    v_lshlrev_b32 v141, 16, v134
    v_sub_f32 v110, v110, v141
    v_sub_f32 v111, v111, v141
    v_sub_f32 v112, v112, v141
    v_sub_f32 v113, v113, v141
    v_sub_f32 v114, v114, v141
    v_sub_f32 v115, v115, v141
    v_sub_f32 v116, v116, v141
    v_sub_f32 v117, v117, v141
    v_cvt_pk_bf16_f32 v134, v110, v111
    v_lshlrev_b32 v110, 16, v134
    v_and_b32 v111, 0xffff0000, v134
    v_cvt_pk_bf16_f32 v134, v112, v113
    v_lshlrev_b32 v112, 16, v134
    v_and_b32 v113, 0xffff0000, v134
    v_cvt_pk_bf16_f32 v134, v114, v115
    v_lshlrev_b32 v114, 16, v134
    v_and_b32 v115, 0xffff0000, v134
    v_cvt_pk_bf16_f32 v134, v116, v117
    v_lshlrev_b32 v116, 16, v134
    v_and_b32 v117, 0xffff0000, v134
    v_mul_f32 v146, v110, v145
    v_fma_f32 v147, -v146, v144, v110
    v_fma_f32 v110, v147, v145, v146
    v_mul_f32 v146, v111, v145
    v_fma_f32 v147, -v146, v144, v111
    v_fma_f32 v111, v147, v145, v146
    v_mul_f32 v146, v112, v145
    v_fma_f32 v147, -v146, v144, v112
    v_fma_f32 v112, v147, v145, v146
    v_mul_f32 v146, v113, v145
    v_fma_f32 v147, -v146, v144, v113
    v_fma_f32 v113, v147, v145, v146
    v_mul_f32 v146, v114, v145
    v_fma_f32 v147, -v146, v144, v114
    v_fma_f32 v114, v147, v145, v146
    v_mul_f32 v146, v115, v145
    v_fma_f32 v147, -v146, v144, v115
    v_fma_f32 v115, v147, v145, v146
    v_mul_f32 v146, v116, v145
    v_fma_f32 v147, -v146, v144, v116
    v_fma_f32 v116, v147, v145, v146
    v_mul_f32 v146, v117, v145
    v_fma_f32 v147, -v146, v144, v117
    v_fma_f32 v117, v147, v145, v146
    v_cvt_pk_bf16_f32 v154, v110, v111
    v_cvt_pk_bf16_f32 v155, v112, v113
    v_cvt_pk_bf16_f32 v156, v114, v115
    v_cvt_pk_bf16_f32 v157, v116, v117
    v_mov_b32 v133, s87
    v_cvt_pk_bf16_f32 v134, v133, v133
    v_lshlrev_b32 v133, 16, v134
    v_mul_f32 v133, 0xbfb8aa3b, v133
    v_exp_f32 v133, v133
    s_nop 0
    v_add_f32 v133, 1.0, v133
    v_rcp_f32 v133, v133
    s_nop 0
    v_cvt_pk_bf16_f32 v134, v133, v133
    v_lshlrev_b32 v133, 16, v134
    s_add_u32 s83, s77, 0
    buffer_store_dwordx4 v[150:153], v2, s[16:19], s83 offen sc1
    buffer_store_dwordx4 v[154:157], v2, s[16:19], s83 offen offset:1024 sc1
    s_lshr_b32 s83, s76, 3
    s_lshl_b32 s83, s83, 7
    s_lshl_b32 s84, s3, 3
    s_add_u32 s83, s83, s84
    s_add_u32 s83, s83, 2097152
    s_mov_b64 exec, 1
    buffer_store_dwordx2 v[132:133], off, s[16:19], s83 sc1
    s_mov_b64 exec, -1
    v_mov_b32 v4, -1
    v_mov_b32 v5, -1
    s_lshl_b32 s95, s72, 12
    s_add_u32 s95, s95, 12582912
    s_mov_b32 s64, s95
    buffer_store_dwordx2 v[4:5], v248, s[16:19], s95 offen sc1
    s_mov_b32 s65, s3
    s_cmp_lg_u32 s3, 0
    s_cbranch_scc1 P1_NOGL
    buffer_load_dword v250, off, s[12:15], 0 sc1
P1_NOGL:
    s_mov_b32 s20, s38
    s_and_b32 s21, s39, 0xffff
    s_mov_b32 s22, 0x400
    s_mov_b32 s23, 0x00020000
    s_mov_b32 s24, s40
    s_and_b32 s25, s41, 0xffff
    s_mov_b32 s26, 0x400
    s_mov_b32 s27, 0x00020000
    s_mov_b32 s28, s50
    s_and_b32 s29, s51, 0xffff
    s_mov_b32 s30, 0x400
    s_mov_b32 s31, 0x00020000
    buffer_load_ushort v180, v14, s[20:23], 0 offen
    buffer_load_ushort v181, v14, s[24:27], 0 offen
    buffer_load_ushort v182, v14, s[28:31], 0 offen
    s_waitcnt vmcnt(37)
    s_barrier
    ds_read_b128 v[72:75], v16 offset:0
    ds_read_b128 v[88:91], v28 offset:16384
    ds_read_b128 v[104:107], v28 offset:20480
    ds_read_b128 v[76:79], v17 offset:0
    ds_read_b128 v[92:95], v29 offset:16384
    ds_read_b128 v[108:111], v29 offset:20480
    ds_read_b128 v[80:83], v18 offset:0
    ds_read_b128 v[96:99], v30 offset:16384
    ds_read_b128 v[112:115], v30 offset:20480
    ds_read_b128 v[84:87], v19 offset:0
    ds_read_b128 v[100:103], v31 offset:16384
    ds_read_b128 v[116:119], v31 offset:20480
    s_waitcnt lgkmcnt(0)
    s_waitcnt vmcnt(31)
    s_barrier
    s_mov_b32 s82, 768
    s_add_u32 m0, s80, 0
    s_nop 0
    buffer_load_dwordx4 v8, s[4:7], s82 offen offset:0 lds
    buffer_load_dwordx4 v9, s[4:7], s82 offen offset:1024 lds
    ds_read_b128 v[120:123], v16 offset:24576
    ds_read_b128 v[136:139], v28 offset:40960
    ds_read_b128 v[152:155], v28 offset:45056
    v_mfma_f32_32x32x16_bf16 v[40:55], v[72:75], v[88:91], 0
    v_mfma_f32_32x32x16_bf16 v[56:71], v[72:75], v[104:107], 0
    buffer_load_dwordx4 v10, s[4:7], s82 offen offset:2048 lds
    buffer_load_dwordx4 v11, s[4:7], s82 offen offset:3072 lds
    ds_read_b128 v[124:127], v17 offset:24576
    ds_read_b128 v[140:143], v29 offset:40960
    ds_read_b128 v[156:159], v29 offset:45056
    v_mfma_f32_32x32x16_bf16 v[40:55], v[76:79], v[92:95], v[40:55]
    v_mfma_f32_32x32x16_bf16 v[56:71], v[76:79], v[108:111], v[56:71]
    s_add_u32 m0, s81, 0
    s_nop 0
    buffer_load_dwordx4 v12, s[8:11], s82 offen offset:0 lds
    ds_read_b128 v[128:131], v18 offset:24576
    ds_read_b128 v[144:147], v30 offset:40960
    ds_read_b128 v[160:163], v30 offset:45056
    v_mfma_f32_32x32x16_bf16 v[40:55], v[80:83], v[96:99], v[40:55]
    v_mfma_f32_32x32x16_bf16 v[56:71], v[80:83], v[112:115], v[56:71]
    buffer_load_dwordx4 v13, s[8:11], s82 offen offset:1024 lds
    ds_read_b128 v[132:135], v19 offset:24576
    ds_read_b128 v[148:151], v31 offset:40960
    ds_read_b128 v[164:167], v31 offset:45056
    v_mfma_f32_32x32x16_bf16 v[40:55], v[84:87], v[100:103], v[40:55]
    v_mfma_f32_32x32x16_bf16 v[56:71], v[84:87], v[116:119], v[56:71]
    s_waitcnt lgkmcnt(0)
    s_waitcnt vmcnt(31)
    s_barrier
    s_mov_b32 s82, 896
    s_add_u32 m0, s80, 24576
    s_nop 0
    buffer_load_dwordx4 v8, s[4:7], s82 offen offset:0 lds
    buffer_load_dwordx4 v9, s[4:7], s82 offen offset:1024 lds
    ds_read_b128 v[72:75], v20 offset:0
    ds_read_b128 v[88:91], v32 offset:16384
    ds_read_b128 v[104:107], v32 offset:20480
    v_mfma_f32_32x32x16_bf16 v[40:55], v[120:123], v[136:139], v[40:55]
    v_mfma_f32_32x32x16_bf16 v[56:71], v[120:123], v[152:155], v[56:71]
    buffer_load_dwordx4 v10, s[4:7], s82 offen offset:2048 lds
    buffer_load_dwordx4 v11, s[4:7], s82 offen offset:3072 lds
    ds_read_b128 v[76:79], v21 offset:0
    ds_read_b128 v[92:95], v33 offset:16384
    ds_read_b128 v[108:111], v33 offset:20480
    v_mfma_f32_32x32x16_bf16 v[40:55], v[124:127], v[140:143], v[40:55]
    v_mfma_f32_32x32x16_bf16 v[56:71], v[124:127], v[156:159], v[56:71]
    s_add_u32 m0, s81, 24576
    s_nop 0
    buffer_load_dwordx4 v12, s[8:11], s82 offen offset:0 lds
    ds_read_b128 v[80:83], v22 offset:0
    ds_read_b128 v[96:99], v34 offset:16384
    ds_read_b128 v[112:115], v34 offset:20480
    v_mfma_f32_32x32x16_bf16 v[40:55], v[128:131], v[144:147], v[40:55]
    v_mfma_f32_32x32x16_bf16 v[56:71], v[128:131], v[160:163], v[56:71]
    buffer_load_dwordx4 v13, s[8:11], s82 offen offset:1024 lds
    ds_read_b128 v[84:87], v23 offset:0
    ds_read_b128 v[100:103], v35 offset:16384
    ds_read_b128 v[116:119], v35 offset:20480
    v_mfma_f32_32x32x16_bf16 v[40:55], v[132:135], v[148:151], v[40:55]
    v_mfma_f32_32x32x16_bf16 v[56:71], v[132:135], v[164:167], v[56:71]
    s_waitcnt lgkmcnt(0)
    s_waitcnt vmcnt(15)
    s_barrier
    s_cmp_lg_u32 s65, 0
    s_cbranch_scc1 P1_NOFH3
    s_waitcnt vmcnt(15)
P1_GOCHK3:
    v_readfirstlane_b32 s84, v250
    s_cmp_lg_u32 s84, 0
    s_cbranch_scc1 P1_GOOK3
    buffer_load_dword v250, off, s[12:15], 0 sc1
    s_branch P1_NOFH3
P1_GOOK3:
    s_mov_b64 exec, 0xffff
    buffer_store_dword v250, v243, s[16:19], s54 offen sc1
    v_mov_b32 v4, 148480
    ds_write_b32 v4, v250
    s_mov_b64 exec, -1
    s_mov_b32 s65, 1
P1_NOFH3:
    s_and_b32 s72, s2, 7
    s_lshr_b32 s73, s2, 3
    s_mov_b32 s101, s73
    s_mul_i32 s74, s72, 22
    s_add_u32 s74, s74, s73
    s_and_b32 s75, s74, 7
    s_lshr_b32 s74, s74, 3
    s_lshl_b32 s100, s75, 7
    s_lshl_b32 s76, s74, 2
    s_add_u32 s100, s100, s76
    s_add_u32 s100, s100, 13664256
    s_lshl_b32 s75, s75, 6
    s_lshl_b32 s74, s74, 6
    s_lshr_b32 s76, s3, 1
    s_and_b32 s77, s3, 1
    v_lshrrev_b32 v2, 5, v1
    v_lshlrev_b32 v2, 3, v2
    s_lshl_b32 s78, s76, 5
    s_add_u32 s78, s78, s74
    s_lshl_b32 s79, s78, 1
    v_add_u32 v2, s79, v2
    v_lshrrev_b32 v4, 3, v1
    v_lshrrev_b32 v5, 4, v1
    v_and_b32 v6, 7, v1
    s_lshl_b32 s80, s3, 4
    s_mov_b32 s81, 2752
    s_lshl_b32 s82, s74, 1
    v_and_b32 v7, 1, v5
    v_lshlrev_b32 v7, 2, v7
    v_xor_b32 v7, v7, v6
    v_lshlrev_b32 v7, 4, v7
    v_add_u32 v8, s80, v4
    v_mul_lo_u32 v8, v8, s81
    v_add_u32 v8, v8, v7
    v_add_u32 v8, s82, v8
    v_and_b32 v7, 1, v5
    v_lshlrev_b32 v7, 2, v7
    v_xor_b32 v7, v7, v6
    v_lshlrev_b32 v7, 4, v7
    v_add_u32 v9, s80, v4
    v_add_u32 v9, 8, v9
    v_mul_lo_u32 v9, v9, s81
    v_add_u32 v9, v9, v7
    v_add_u32 v9, s82, v9
    v_subrev_u32 v9, 1024, v9
    s_mov_b32 s81, 1024
    s_lshl_b32 s82, s75, 1
    s_add_u32 s82, s82, 0
    v_and_b32 v7, 1, v5
    v_lshlrev_b32 v7, 2, v7
    v_xor_b32 v7, v7, v6
    v_lshlrev_b32 v7, 4, v7
    v_add_u32 v10, s80, v4
    v_mul_lo_u32 v10, v10, s81
    v_add_u32 v10, v10, v7
    v_add_u32 v10, s82, v10
    v_and_b32 v7, 1, v5
    v_lshlrev_b32 v7, 2, v7
    v_xor_b32 v7, v7, v6
    v_lshlrev_b32 v7, 4, v7
    v_add_u32 v11, s80, v4
    v_add_u32 v11, 8, v11
    v_mul_lo_u32 v11, v11, s81
    v_add_u32 v11, v11, v7
    v_add_u32 v11, s82, v11
    v_subrev_u32 v11, 1024, v11
    s_lshl_b32 s83, s3, 11
    s_mov_b32 s4, s56
    s_and_b32 s5, s57, 0xffff
    s_mov_b32 s6, 0x560000
    s_mov_b32 s7, 0x00020000
    s_cmp_lt_u32 s73, 22
    s_cselect_b32 s6, s6, 0
    s_mov_b32 s84, 0
    s_add_u32 m0, s83, 49152
    s_nop 0
    buffer_load_dwordx4 v8, s[4:7], s84 offen lds
    ds_read_b128 v[120:123], v20 offset:24576
    ds_read_b128 v[136:139], v32 offset:40960
    ds_read_b128 v[152:155], v32 offset:45056
    v_mfma_f32_32x32x16_bf16 v[40:55], v[72:75], v[88:91], v[40:55]
    v_mfma_f32_32x32x16_bf16 v[56:71], v[72:75], v[104:107], v[56:71]
    buffer_load_dwordx4 v9, s[4:7], s84 offen offset:1024 lds
    ds_read_b128 v[124:127], v21 offset:24576
    ds_read_b128 v[140:143], v33 offset:40960
    ds_read_b128 v[156:159], v33 offset:45056
    v_mfma_f32_32x32x16_bf16 v[40:55], v[76:79], v[92:95], v[40:55]
    v_mfma_f32_32x32x16_bf16 v[56:71], v[76:79], v[108:111], v[56:71]
    s_mov_b32 s84, 176128
    s_add_u32 m0, s83, 65536
    s_nop 0
    buffer_load_dwordx4 v8, s[4:7], s84 offen lds
    ds_read_b128 v[128:131], v22 offset:24576
    ds_read_b128 v[144:147], v34 offset:40960
    ds_read_b128 v[160:163], v34 offset:45056
    v_mfma_f32_32x32x16_bf16 v[40:55], v[80:83], v[96:99], v[40:55]
    v_mfma_f32_32x32x16_bf16 v[56:71], v[80:83], v[112:115], v[56:71]
    buffer_load_dwordx4 v9, s[4:7], s84 offen offset:1024 lds
    ds_read_b128 v[132:135], v23 offset:24576
    ds_read_b128 v[148:151], v35 offset:40960
    ds_read_b128 v[164:167], v35 offset:45056
    v_mfma_f32_32x32x16_bf16 v[40:55], v[84:87], v[100:103], v[40:55]
    v_mfma_f32_32x32x16_bf16 v[56:71], v[84:87], v[116:119], v[56:71]
    s_mov_b32 s20, s56
    s_and_b32 s21, s57, 0xffff
    s_mov_b32 s22, 0x560000
    s_mov_b32 s23, 0x00020000
    s_lshr_b32 s90, s2, 3
    s_lshl_b32 s90, s90, 6
    s_lshl_b32 s91, s3, 4
    s_add_u32 s90, s90, s91
    s_and_b32 s92, s2, 7
    s_mul_i32 s92, s92, 22
    s_lshr_b32 s92, s92, 3
    s_lshl_b32 s92, s92, 7
    s_mov_b32 s93, 2752
    v_lshrrev_b32 v4, 2, v1
    v_add_u32 v4, s90, v4
    v_mul_lo_u32 v4, v4, s93
    v_and_b32 v5, 3, v1
    v_lshl_add_u32 v4, v5, 7, v4
    buffer_load_dword v198, v4, s[20:23], s92 offen
    v_and_b32 v4, 15, v1
    v_add_u32 v4, s90, v4
    v_mul_lo_u32 v4, v4, s93
    buffer_load_dword v198, v4, s[20:23], s92 offen offset:512
    s_waitcnt lgkmcnt(0)
    s_barrier
    s_cmp_lg_u32 s65, 0
    s_cbranch_scc1 P1_NOFH4
    s_waitcnt vmcnt(6)
P1_GOCHK4:
    v_readfirstlane_b32 s84, v250
    s_cmp_lg_u32 s84, 0
    s_cbranch_scc1 P1_GOOK4
    buffer_load_dword v250, off, s[12:15], 0 sc1
    s_branch P1_NOFH4
P1_GOOK4:
    s_mov_b64 exec, 0xffff
    buffer_store_dword v250, v243, s[16:19], s54 offen sc1
    v_mov_b32 v4, 148480
    ds_write_b32 v4, v250
    s_mov_b64 exec, -1
    s_mov_b32 s65, 1
P1_NOFH4:
    s_mov_b32 s84, 352256
    s_add_u32 m0, s83, 81920
    s_nop 0
    buffer_load_dwordx4 v8, s[4:7], s84 offen lds
    ds_read_b128 v[72:75], v24 offset:0
    ds_read_b128 v[88:91], v36 offset:16384
    ds_read_b128 v[104:107], v36 offset:20480
    v_mfma_f32_32x32x16_bf16 v[40:55], v[120:123], v[136:139], v[40:55]
    v_mfma_f32_32x32x16_bf16 v[56:71], v[120:123], v[152:155], v[56:71]
    buffer_load_dwordx4 v9, s[4:7], s84 offen offset:1024 lds
    ds_read_b128 v[76:79], v25 offset:0
    ds_read_b128 v[92:95], v37 offset:16384
    ds_read_b128 v[108:111], v37 offset:20480
    v_mfma_f32_32x32x16_bf16 v[40:55], v[124:127], v[140:143], v[40:55]
    v_mfma_f32_32x32x16_bf16 v[56:71], v[124:127], v[156:159], v[56:71]
    ds_read_b128 v[80:83], v26 offset:0
    ds_read_b128 v[96:99], v38 offset:16384
    ds_read_b128 v[112:115], v38 offset:20480
    v_mfma_f32_32x32x16_bf16 v[40:55], v[128:131], v[144:147], v[40:55]
    v_mfma_f32_32x32x16_bf16 v[56:71], v[128:131], v[160:163], v[56:71]
    ds_read_b128 v[84:87], v27 offset:0
    ds_read_b128 v[100:103], v39 offset:16384
    ds_read_b128 v[116:119], v39 offset:20480
    v_mfma_f32_32x32x16_bf16 v[40:55], v[132:135], v[148:151], v[40:55]
    v_mfma_f32_32x32x16_bf16 v[56:71], v[132:135], v[164:167], v[56:71]
    s_waitcnt lgkmcnt(0)
    s_barrier
    s_cmp_lg_u32 s65, 0
    s_cbranch_scc1 P1_NOFH5
    s_waitcnt vmcnt(2)
P1_GOCHK5:
    v_readfirstlane_b32 s84, v250
    s_cmp_lg_u32 s84, 0
    s_cbranch_scc1 P1_GOOK5
    buffer_load_dword v250, off, s[12:15], 0 sc1
    s_branch P1_NOFH5
P1_GOOK5:
    s_mov_b64 exec, 0xffff
    buffer_store_dword v250, v243, s[16:19], s54 offen sc1
    v_mov_b32 v4, 148480
    ds_write_b32 v4, v250
    s_mov_b64 exec, -1
    s_mov_b32 s65, 1
P1_NOFH5:
    s_mov_b32 s84, 528384
    s_add_u32 m0, s83, 98304
    s_nop 0
    buffer_load_dwordx4 v8, s[4:7], s84 offen lds
    ds_read_b128 v[120:123], v24 offset:24576
    ds_read_b128 v[136:139], v36 offset:40960
    ds_read_b128 v[152:155], v36 offset:45056
    v_mfma_f32_32x32x16_bf16 v[40:55], v[72:75], v[88:91], v[40:55]
    v_mfma_f32_32x32x16_bf16 v[56:71], v[72:75], v[104:107], v[56:71]
    buffer_load_dwordx4 v9, s[4:7], s84 offen offset:1024 lds
    ds_read_b128 v[124:127], v25 offset:24576
    ds_read_b128 v[140:143], v37 offset:40960
    ds_read_b128 v[156:159], v37 offset:45056
    v_mfma_f32_32x32x16_bf16 v[40:55], v[76:79], v[92:95], v[40:55]
    v_mfma_f32_32x32x16_bf16 v[56:71], v[76:79], v[108:111], v[56:71]
    s_mov_b32 s84, 704512
    s_add_u32 m0, s83, 114688
    s_nop 0
    buffer_load_dwordx4 v8, s[4:7], s84 offen lds
    ds_read_b128 v[128:131], v26 offset:24576
    ds_read_b128 v[144:147], v38 offset:40960
    ds_read_b128 v[160:163], v38 offset:45056
    v_mfma_f32_32x32x16_bf16 v[40:55], v[80:83], v[96:99], v[40:55]
    v_mfma_f32_32x32x16_bf16 v[56:71], v[80:83], v[112:115], v[56:71]
    buffer_load_dwordx4 v9, s[4:7], s84 offen offset:1024 lds
    ds_read_b128 v[132:135], v27 offset:24576
    ds_read_b128 v[148:151], v39 offset:40960
    ds_read_b128 v[164:167], v39 offset:45056
    v_mfma_f32_32x32x16_bf16 v[40:55], v[84:87], v[100:103], v[40:55]
    v_mfma_f32_32x32x16_bf16 v[56:71], v[84:87], v[116:119], v[56:71]
    s_waitcnt vmcnt(24)
    v_lshlrev_b32 v180, 16, v180
    v_lshlrev_b32 v181, 16, v181
    v_lshlrev_b32 v182, 16, v182
    v_mul_f32 v192, 0x3fb8aa3b, v182
    v_exp_f32 v192, v192
    s_nop 0
    v_cvt_pk_bf16_f32 v193, v192, v192
    v_lshlrev_b32 v192, 16, v193
    v_mul_f32 v193, v192, v180
    v_mul_f32 v192, v192, v181
    v_mul_f32 v193, 0x3fb8aa3b, v193
    v_mul_f32 v192, 0x3e22f983, v192
    v_exp_f32 v193, v193
    v_fract_f32 v192, v192
    v_cos_f32 v184, v192
    v_sin_f32 v185, v192
    s_nop 0
    v_mul_f32 v184, v184, v193
    v_mul_f32 v185, v185, v193
    v_mul_f32 v186, v184, v184
    v_mul_f32 v187, v184, v185
    v_fma_f32 v186, -v185, v185, v186
    v_fma_f32 v187, v185, v184, v187
    v_mul_f32 v188, v186, v184
    v_mul_f32 v189, v186, v185
    v_fma_f32 v188, -v187, v185, v188
    v_fma_f32 v189, v187, v184, v189
    v_mul_f32 v190, v186, v186
    v_mul_f32 v191, v186, v187
    v_fma_f32 v190, -v187, v187, v190
    v_fma_f32 v191, v187, v186, v191
    s_waitcnt lgkmcnt(0)
    s_waitcnt vmcnt(18)
    s_barrier
    s_cmp_lg_u32 s65, 0
    s_cbranch_scc1 P1_NOFH6
    s_waitcnt vmcnt(4)
P1_GOCHK6:
    v_readfirstlane_b32 s84, v250
    s_cmp_lg_u32 s84, 0
    s_cbranch_scc1 P1_GOOK6
    buffer_load_dword v250, off, s[12:15], 0 sc1
    s_branch P1_NOFH6
P1_GOOK6:
    s_mov_b64 exec, 0xffff
    buffer_store_dword v250, v243, s[16:19], s54 offen sc1
    v_mov_b32 v4, 148480
    ds_write_b32 v4, v250
    s_mov_b64 exec, -1
    s_mov_b32 s65, 1
P1_NOFH6:
    ds_read_b128 v[72:75], v16 offset:0
    ds_read_b128 v[88:91], v28 offset:16384
    ds_read_b128 v[104:107], v28 offset:20480
    v_mfma_f32_32x32x16_bf16 v[40:55], v[120:123], v[136:139], v[40:55]
    v_mfma_f32_32x32x16_bf16 v[56:71], v[120:123], v[152:155], v[56:71]
    ds_read_b128 v[76:79], v17 offset:0
    ds_read_b128 v[92:95], v29 offset:16384
    ds_read_b128 v[108:111], v29 offset:20480
    v_mfma_f32_32x32x16_bf16 v[40:55], v[124:127], v[140:143], v[40:55]
    v_mfma_f32_32x32x16_bf16 v[56:71], v[124:127], v[156:159], v[56:71]
    ds_read_b128 v[80:83], v18 offset:0
    ds_read_b128 v[96:99], v30 offset:16384
    ds_read_b128 v[112:115], v30 offset:20480
    v_mfma_f32_32x32x16_bf16 v[40:55], v[128:131], v[144:147], v[40:55]
    v_mfma_f32_32x32x16_bf16 v[56:71], v[128:131], v[160:163], v[56:71]
    ds_read_b128 v[84:87], v19 offset:0
    ds_read_b128 v[100:103], v31 offset:16384
    ds_read_b128 v[116:119], v31 offset:20480
    v_mfma_f32_32x32x16_bf16 v[40:55], v[132:135], v[148:151], v[40:55]
    v_mfma_f32_32x32x16_bf16 v[56:71], v[132:135], v[164:167], v[56:71]
    v_mul_f32 v194, v190, v190
    v_mul_f32 v195, v190, v191
    v_fma_f32 v194, -v191, v191, v194
    v_fma_f32 v195, v191, v190, v195
    v_mul_f32 v196, v194, v194
    v_mul_f32 v197, v194, v195
    v_fma_f32 v196, -v195, v195, v196
    v_fma_f32 v197, v195, v194, v197
    v_mul_f32 v194, v196, v196
    v_mul_f32 v195, v196, v197
    v_fma_f32 v194, -v197, v197, v194
    v_fma_f32 v195, v197, v196, v195
    v_mul_f32 v236, v194, v194
    v_mul_f32 v237, v194, v195
    v_fma_f32 v236, -v195, v195, v236
    v_fma_f32 v237, v195, v194, v237
    v_mul_f32 v238, v236, v236
    v_mul_f32 v239, v236, v237
    v_fma_f32 v238, -v237, v237, v238
    v_fma_f32 v239, v237, v236, v239
    v_add_f32 v192, -1.0, v184
    v_mul_f32 v193, v180, v180
    v_fmac_f32 v193, v181, v181
    v_rcp_f32 v193, v193
    v_mul_f32 v234, v192, v180
    v_fmac_f32 v234, v185, v181
    v_mul_f32 v235, v185, v180
    v_fma_f32 v235, -v192, v181, v235
    v_add_f32 v193, v193, v193
    v_mul_f32 v234, v234, v193
    v_mul_f32 v235, v235, v193
    s_waitcnt lgkmcnt(0)
    s_waitcnt vmcnt(12)
    s_barrier
    s_cmp_lg_u32 s65, 0
    s_cbranch_scc1 P1_NOFH7
    s_waitcnt vmcnt(0)
P1_GOCHK7:
    v_readfirstlane_b32 s84, v250
    s_cmp_lg_u32 s84, 0
    s_cbranch_scc1 P1_GOOK7
    s_cmp_eq_u32 s96, 0
    s_cbranch_scc1 P1_GOOK7
    s_sub_u32 s96, s96, 1
    s_sleep 1
    buffer_load_dword v250, off, s[12:15], 0 sc1
    s_waitcnt vmcnt(0)
    s_branch P1_GOCHK7
P1_GOOK7:
    s_mov_b64 exec, 0xffff
    buffer_store_dword v250, v243, s[16:19], s54 offen sc1
    v_mov_b32 v4, 148480
    ds_write_b32 v4, v250
    s_mov_b64 exec, -1
    s_mov_b32 s65, 1
P1_NOFH7:
    s_mov_b32 s84, 880640
    s_add_u32 m0, s83, 0
    s_nop 0
    buffer_load_dwordx4 v8, s[4:7], s84 offen lds
    ds_read_b128 v[120:123], v16 offset:24576
    ds_read_b128 v[136:139], v28 offset:40960
    ds_read_b128 v[152:155], v28 offset:45056
    v_mfma_f32_32x32x16_bf16 v[40:55], v[72:75], v[88:91], v[40:55]
    v_mfma_f32_32x32x16_bf16 v[56:71], v[72:75], v[104:107], v[56:71]
    buffer_load_dwordx4 v9, s[4:7], s84 offen offset:1024 lds
    ds_read_b128 v[124:127], v17 offset:24576
    ds_read_b128 v[140:143], v29 offset:40960
    ds_read_b128 v[156:159], v29 offset:45056
    v_mfma_f32_32x32x16_bf16 v[40:55], v[76:79], v[92:95], v[40:55]
    v_mfma_f32_32x32x16_bf16 v[56:71], v[76:79], v[108:111], v[56:71]
    s_mov_b32 s84, 1056768
    s_add_u32 m0, s83, 16384
    s_nop 0
    buffer_load_dwordx4 v8, s[4:7], s84 offen lds
    ds_read_b128 v[128:131], v18 offset:24576
    ds_read_b128 v[144:147], v30 offset:40960
    ds_read_b128 v[160:163], v30 offset:45056
    v_mfma_f32_32x32x16_bf16 v[40:55], v[80:83], v[96:99], v[40:55]
    v_mfma_f32_32x32x16_bf16 v[56:71], v[80:83], v[112:115], v[56:71]
    buffer_load_dwordx4 v9, s[4:7], s84 offen offset:1024 lds
    ds_read_b128 v[132:135], v19 offset:24576
    ds_read_b128 v[148:151], v31 offset:40960
    ds_read_b128 v[164:167], v31 offset:45056
    v_mfma_f32_32x32x16_bf16 v[40:55], v[84:87], v[100:103], v[40:55]
    v_mfma_f32_32x32x16_bf16 v[56:71], v[84:87], v[116:119], v[56:71]
    s_waitcnt lgkmcnt(0)
    v_mfma_f32_32x32x16_bf16 v[40:55], v[120:123], v[136:139], v[40:55]
    v_mfma_f32_32x32x16_bf16 v[56:71], v[120:123], v[152:155], v[56:71]
    v_mfma_f32_32x32x16_bf16 v[40:55], v[124:127], v[140:143], v[40:55]
    v_mfma_f32_32x32x16_bf16 v[56:71], v[124:127], v[156:159], v[56:71]
    v_mfma_f32_32x32x16_bf16 v[40:55], v[128:131], v[144:147], v[40:55]
    v_mfma_f32_32x32x16_bf16 v[56:71], v[128:131], v[160:163], v[56:71]
    v_mfma_f32_32x32x16_bf16 v[40:55], v[132:135], v[148:151], v[40:55]
    v_mfma_f32_32x32x16_bf16 v[56:71], v[132:135], v[164:167], v[56:71]
    buffer_load_dword v244, v246, s[16:19], s55 offen sc1
    v_lshlrev_b32 v247, 3, v3
    v_add_u32 v247, 147456, v247
    s_lshl_b32 s84, s3, 8
    v_add_u32 v7, s84, v247
    s_lshl_b32 s86, s76, 2
    s_lshl_b32 s87, s77, 2
    v_and_b32 v16, 15, v1
    v_lshrrev_b32 v17, 4, v1
    v_and_b32 v17, 1, v17
    v_lshlrev_b32 v17, 1, v17
    v_bfe_u32 v18, v16, 1, 1
    v_add_u32 v17, v17, v18
    v_add_u32 v17, s86, v17
    v_bfe_u32 v18, v16, 3, 1
    v_lshlrev_b32 v18, 2, v18
    v_xor_b32 v17, v17, v18
    v_lshlrev_b32 v17, 4, v17
    v_and_b32 v18, 1, v16
    v_lshl_add_u32 v17, v18, 3, v17
    v_lshrrev_b32 v18, 2, v16
    v_lshrrev_b32 v16, 5, v1
    v_lshl_add_u32 v18, v16, 3, v18
    v_lshl_add_u32 v12, v18, 7, v17
    v_add_u32 v13, 65536, v12
    v_and_b32 v16, 15, v1
    v_lshrrev_b32 v17, 4, v1
    v_and_b32 v17, 1, v17
    v_lshlrev_b32 v17, 1, v17
    v_bfe_u32 v18, v16, 1, 1
    v_add_u32 v17, v17, v18
    v_add_u32 v17, s87, v17
    v_bfe_u32 v18, v16, 3, 1
    v_lshlrev_b32 v18, 2, v18
    v_xor_b32 v17, v17, v18
    v_lshlrev_b32 v17, 4, v17
    v_and_b32 v18, 1, v16
    v_lshl_add_u32 v17, v18, 3, v17
    v_lshrrev_b32 v18, 2, v16
    v_lshrrev_b32 v16, 5, v1
    v_lshl_add_u32 v18, v16, 3, v18
    v_lshl_add_u32 v14, v18, 7, v17
    v_add_u32 v14, 8192, v14
    v_add_u32 v15, 65536, v14
    v_add_u32 v12, s83, v12
    v_xor_b32 v32, 64, v12
    v_add_u32 v13, s83, v13
    v_xor_b32 v33, 64, v13
    v_add_u32 v14, s83, v14
    v_xor_b32 v34, 64, v14
    v_add_u32 v15, s83, v15
    v_xor_b32 v35, 64, v15
    v_and_b32 v4, 31, v1
    s_lshl_b32 s89, s77, 5
    s_add_u32 s89, s89, s75
    v_add_u32 v4, s89, v4
    s_mov_b32 s90, 2816
    v_mul_lo_u32 v4, v4, s90
    v_add_u32 v199, v4, v2
    v_lshrrev_b32 v4, 2, v1
    v_add_u32 v4, s89, v4
    v_mul_lo_u32 v4, v4, s90
    v_and_b32 v5, 3, v1
    v_lshl_add_u32 v4, v5, 4, v4
    v_add_u32 v199, s79, v4
    s_mov_b32 s8, s58
    s_and_b32 s9, s59, 0xffff
    s_mov_b32 s10, 0xac0
    s_mov_b32 s11, 0x00020000
    s_mov_b32 s93, s78
    v_fma_f32 v41, v184, v40, v41
    v_fma_f32 v57, v184, v56, v57
    v_fma_f32 v41, -v185, v56, v41
    v_fma_f32 v57, v185, v40, v57
    v_fma_f32 v45, v184, v44, v45
    v_fma_f32 v61, v184, v60, v61
    v_fma_f32 v45, -v185, v60, v45
    v_fma_f32 v61, v185, v44, v61
    v_fma_f32 v49, v184, v48, v49
    v_fma_f32 v65, v184, v64, v65
    v_fma_f32 v49, -v185, v64, v49
    v_fma_f32 v65, v185, v48, v65
    v_fma_f32 v53, v184, v52, v53
    v_fma_f32 v69, v184, v68, v69
    v_fma_f32 v53, -v185, v68, v53
    v_fma_f32 v69, v185, v52, v69
    v_fma_f32 v42, v184, v41, v42
    v_fma_f32 v58, v184, v57, v58
    v_fma_f32 v42, -v185, v57, v42
    v_fma_f32 v58, v185, v41, v58
    v_fma_f32 v46, v184, v45, v46
    v_fma_f32 v62, v184, v61, v62
    v_fma_f32 v46, -v185, v61, v46
    v_fma_f32 v62, v185, v45, v62
    v_fma_f32 v50, v184, v49, v50
    v_fma_f32 v66, v184, v65, v66
    v_fma_f32 v50, -v185, v65, v50
    v_fma_f32 v66, v185, v49, v66
    v_fma_f32 v54, v184, v53, v54
    v_fma_f32 v70, v184, v69, v70
    v_fma_f32 v54, -v185, v69, v54
    v_fma_f32 v70, v185, v53, v70
    v_fma_f32 v43, v184, v42, v43
    v_fma_f32 v59, v184, v58, v59
    v_fma_f32 v43, -v185, v58, v43
    v_fma_f32 v59, v185, v42, v59
    v_fma_f32 v47, v184, v46, v47
    v_fma_f32 v63, v184, v62, v63
    v_fma_f32 v47, -v185, v62, v47
    v_fma_f32 v63, v185, v46, v63
    v_fma_f32 v51, v184, v50, v51
    v_fma_f32 v67, v184, v66, v67
    v_fma_f32 v51, -v185, v66, v51
    v_fma_f32 v67, v185, v50, v67
    v_fma_f32 v55, v184, v54, v55
    v_fma_f32 v71, v184, v70, v71
    v_fma_f32 v55, -v185, v70, v55
    v_fma_f32 v71, v185, v54, v71
    v_mov_b32 v72, v43
    v_mov_b32 v80, v43
    v_mov_b32 v76, v59
    v_mov_b32 v84, v59
    v_mov_b32 v73, v47
    v_mov_b32 v81, v47
    v_mov_b32 v77, v63
    v_mov_b32 v85, v63
    v_mov_b32 v74, v51
    v_mov_b32 v82, v51
    v_mov_b32 v78, v67
    v_mov_b32 v86, v67
    v_mov_b32 v75, v55
    v_mov_b32 v83, v55
    v_mov_b32 v79, v71
    v_mov_b32 v87, v71
    s_nop 1
    v_permlane32_swap_b32 v72, v80
    v_permlane32_swap_b32 v73, v81
    v_permlane32_swap_b32 v74, v82
    v_permlane32_swap_b32 v75, v83
    v_permlane32_swap_b32 v76, v84
    v_permlane32_swap_b32 v77, v85
    v_permlane32_swap_b32 v78, v86
    v_permlane32_swap_b32 v79, v87
    s_nop 1
    v_fma_f32 v89, v190, v72, v80
    v_fma_f32 v98, v190, v76, v84
    v_fma_f32 v89, -v191, v76, v89
    v_fma_f32 v98, v191, v72, v98
    v_fma_f32 v90, v190, v89, v73
    v_fma_f32 v99, v190, v98, v77
    v_fma_f32 v90, -v191, v98, v90
    v_fma_f32 v99, v191, v89, v99
    v_fma_f32 v91, v190, v90, v81
    v_fma_f32 v100, v190, v99, v85
    v_fma_f32 v91, -v191, v99, v91
    v_fma_f32 v100, v191, v90, v100
    v_fma_f32 v92, v190, v91, v74
    v_fma_f32 v101, v190, v100, v78
    v_fma_f32 v92, -v191, v100, v92
    v_fma_f32 v101, v191, v91, v101
    v_fma_f32 v93, v190, v92, v82
    v_fma_f32 v102, v190, v101, v86
    v_fma_f32 v93, -v191, v101, v93
    v_fma_f32 v102, v191, v92, v102
    v_fma_f32 v94, v190, v93, v75
    v_fma_f32 v103, v190, v102, v79
    v_fma_f32 v94, -v191, v102, v94
    v_fma_f32 v103, v191, v93, v103
    v_fma_f32 v126, v190, v94, v83
    v_fma_f32 v127, v190, v103, v87
    v_fma_f32 v126, -v191, v103, v126
    v_fma_f32 v127, v191, v94, v127
    ds_write_b64 v7, v[126:127]
    s_waitcnt lgkmcnt(0)
    s_barrier
    ds_read_b64 v[110:111], v247 offset:0
    ds_read_b64 v[112:113], v247 offset:256
    ds_read_b64 v[114:115], v247 offset:512
    ds_read_b64 v[116:117], v247 offset:768
    v_mov_b32 v4, 148480
    ds_read_b32 v250, v4
    s_waitcnt lgkmcnt(0)
    v_fma_f32 v118, v194, v110, v112
    v_fma_f32 v119, v194, v111, v113
    v_fma_f32 v118, -v195, v111, v118
    v_fma_f32 v119, v195, v110, v119
    v_fma_f32 v120, v194, v118, v114
    v_fma_f32 v121, v194, v119, v115
    v_fma_f32 v120, -v195, v119, v120
    v_fma_f32 v121, v195, v118, v121
    v_fma_f32 v122, v194, v120, v116
    v_fma_f32 v123, v194, v121, v117
    v_fma_f32 v122, -v195, v121, v122
    v_fma_f32 v123, v195, v120, v123
    buffer_store_dwordx2 v[122:123], v248, s[16:19], s64 offen sc1
    s_mov_b32 s84, 1232896
    s_add_u32 m0, s83, 32768
    s_nop 0
    buffer_load_dwordx4 v8, s[4:7], s84 offen lds
    buffer_load_dwordx4 v9, s[4:7], s84 offen offset:1024 lds
    s_waitcnt vmcnt(3)
P1_FHCHK:
    v_cmp_ne_u32 vcc, v250, v244
    s_cbranch_vccz P1_FHOK
    s_cmp_eq_u32 s96, 0
    s_cbranch_scc1 P1_FHOK
    s_sub_u32 s96, s96, 1
    s_sleep 1
    buffer_load_dword v244, v246, s[16:19], s55 offen sc1
    s_waitcnt vmcnt(0)
    s_branch P1_FHCHK
P1_FHOK:
    s_barrier
    s_cmp_lt_u32 s73, 22
    s_cbranch_scc1 F_ROLE
    s_mov_b32 s12, s70
    s_and_b32 s13, s71, 0xffff
    s_mov_b32 s14, 0x200000
    s_mov_b32 s15, 0x00020000
    s_sub_u32 s74, s73, 22
    s_cmp_eq_u32 s3, 0
    s_cbranch_scc1 R_NOPF
    s_mul_i32 s74, s74, 192
    s_sub_u32 s74, s74, 64
    v_add_u32 v4, s74, v0
    v_lshlrev_b32 v5, 7, v4
    s_mov_b32 s84, 0
    buffer_load_dword v231, v5, s[12:15], s84 offen
    s_mov_b32 s84, 245760
    buffer_load_dword v231, v5, s[12:15], s84 offen
    s_mov_b32 s84, 491520
    buffer_load_dword v231, v5, s[12:15], s84 offen
    s_mov_b32 s84, 737280
    buffer_load_dword v231, v5, s[12:15], s84 offen
    s_mov_b32 s84, 983040
    buffer_load_dword v231, v5, s[12:15], s84 offen
    s_mov_b32 s84, 1228800
    buffer_load_dword v231, v5, s[12:15], s84 offen
    s_mov_b32 s84, 1474560
    buffer_load_dword v231, v5, s[12:15], s84 offen
    s_mov_b32 s84, 1720320
    buffer_load_dword v231, v5, s[12:15], s84 offen
    s_mov_b32 s84, 1966080
    buffer_load_dword v231, v5, s[12:15], s84 offen
R_NOPF:
    s_cmp_lg_u32 s3, 0
    s_cbranch_scc1 ELXR
    s_cmp_le_u32 s97, 0
    s_cbranch_scc1 ELR_0
    s_mov_b32 s84, 12582912
    buffer_load_dwordx2 v[200:201], v248, s[16:19], s84 offen sc1
    s_cmp_le_u32 s97, 1
    s_cbranch_scc1 ELR_0
    s_mov_b32 s84, 12587008
    buffer_load_dwordx2 v[202:203], v248, s[16:19], s84 offen sc1
    s_cmp_le_u32 s97, 2
    s_cbranch_scc1 ELR_0
    s_mov_b32 s84, 12591104
    buffer_load_dwordx2 v[204:205], v248, s[16:19], s84 offen sc1
    s_cmp_le_u32 s97, 3
    s_cbranch_scc1 ELR_0
    s_mov_b32 s84, 12595200
    buffer_load_dwordx2 v[206:207], v248, s[16:19], s84 offen sc1
    s_cmp_le_u32 s97, 4
    s_cbranch_scc1 ELR_0
    s_mov_b32 s84, 12599296
    buffer_load_dwordx2 v[208:209], v248, s[16:19], s84 offen sc1
    s_cmp_le_u32 s97, 5
    s_cbranch_scc1 ELR_0
    s_mov_b32 s84, 12603392
    buffer_load_dwordx2 v[210:211], v248, s[16:19], s84 offen sc1
    s_cmp_le_u32 s97, 6
    s_cbranch_scc1 ELR_0
    s_mov_b32 s84, 12607488
    buffer_load_dwordx2 v[212:213], v248, s[16:19], s84 offen sc1
    s_cmp_le_u32 s97, 7
    s_cbranch_scc1 ELR_0
    s_mov_b32 s84, 12611584
    buffer_load_dwordx2 v[214:215], v248, s[16:19], s84 offen sc1
    s_cmp_le_u32 s97, 8
    s_cbranch_scc1 ELR_0
    s_mov_b32 s84, 12615680
    buffer_load_dwordx2 v[216:217], v248, s[16:19], s84 offen sc1
    s_cmp_le_u32 s97, 9
    s_cbranch_scc1 ELR_0
    s_mov_b32 s84, 12619776
    buffer_load_dwordx2 v[218:219], v248, s[16:19], s84 offen sc1
    s_cmp_le_u32 s97, 10
    s_cbranch_scc1 ELR_0
    s_mov_b32 s84, 12623872
    buffer_load_dwordx2 v[220:221], v248, s[16:19], s84 offen sc1
    s_cmp_le_u32 s97, 11
    s_cbranch_scc1 ELR_0
    s_mov_b32 s84, 12627968
    buffer_load_dwordx2 v[222:223], v248, s[16:19], s84 offen sc1
    s_cmp_le_u32 s97, 12
    s_cbranch_scc1 ELR_0
    s_mov_b32 s84, 12632064
    buffer_load_dwordx2 v[224:225], v248, s[16:19], s84 offen sc1
    s_cmp_le_u32 s97, 13
    s_cbranch_scc1 ELR_0
    s_mov_b32 s84, 12636160
    buffer_load_dwordx2 v[226:227], v248, s[16:19], s84 offen sc1
    s_cmp_le_u32 s97, 14
    s_cbranch_scc1 ELR_0
    s_mov_b32 s84, 12640256
    buffer_load_dwordx2 v[228:229], v248, s[16:19], s84 offen sc1
    ELR_0:
ELXR:
    v_mul_f32 v124, v235, v40
    v_mul_f32 v40, v234, v40
    v_fma_f32 v40, -v235, v56, v40
    v_fma_f32 v56, -v234, v56, -v124
    v_mul_f32 v124, v235, v41
    v_mul_f32 v41, v234, v41
    v_fma_f32 v41, -v235, v57, v41
    v_fma_f32 v57, -v234, v57, -v124
    v_mul_f32 v124, v235, v42
    v_mul_f32 v42, v234, v42
    v_fma_f32 v42, -v235, v58, v42
    v_fma_f32 v58, -v234, v58, -v124
    v_mul_f32 v124, v235, v43
    v_mul_f32 v43, v234, v43
    v_fma_f32 v43, -v235, v59, v43
    v_fma_f32 v59, -v234, v59, -v124
    v_mul_f32 v124, v235, v44
    v_mul_f32 v44, v234, v44
    v_fma_f32 v44, -v235, v60, v44
    v_fma_f32 v60, -v234, v60, -v124
    v_mul_f32 v124, v235, v45
    v_mul_f32 v45, v234, v45
    v_fma_f32 v45, -v235, v61, v45
    v_fma_f32 v61, -v234, v61, -v124
    v_mul_f32 v124, v235, v46
    v_mul_f32 v46, v234, v46
    v_fma_f32 v46, -v235, v62, v46
    v_fma_f32 v62, -v234, v62, -v124
    v_mul_f32 v124, v235, v47
    v_mul_f32 v47, v234, v47
    v_fma_f32 v47, -v235, v63, v47
    v_fma_f32 v63, -v234, v63, -v124
    v_mul_f32 v124, v235, v48
    v_mul_f32 v48, v234, v48
    v_fma_f32 v48, -v235, v64, v48
    v_fma_f32 v64, -v234, v64, -v124
    v_mul_f32 v124, v235, v49
    v_mul_f32 v49, v234, v49
    v_fma_f32 v49, -v235, v65, v49
    v_fma_f32 v65, -v234, v65, -v124
    v_mul_f32 v124, v235, v50
    v_mul_f32 v50, v234, v50
    v_fma_f32 v50, -v235, v66, v50
    v_fma_f32 v66, -v234, v66, -v124
    v_mul_f32 v124, v235, v51
    v_mul_f32 v51, v234, v51
    v_fma_f32 v51, -v235, v67, v51
    v_fma_f32 v67, -v234, v67, -v124
    v_mul_f32 v124, v235, v52
    v_mul_f32 v52, v234, v52
    v_fma_f32 v52, -v235, v68, v52
    v_fma_f32 v68, -v234, v68, -v124
    v_mul_f32 v124, v235, v53
    v_mul_f32 v53, v234, v53
    v_fma_f32 v53, -v235, v69, v53
    v_fma_f32 v69, -v234, v69, -v124
    v_mul_f32 v124, v235, v54
    v_mul_f32 v54, v234, v54
    v_fma_f32 v54, -v235, v70, v54
    v_fma_f32 v70, -v234, v70, -v124
    v_mul_f32 v124, v235, v55
    v_mul_f32 v55, v234, v55
    v_fma_f32 v55, -v235, v71, v55
    v_fma_f32 v71, -v234, v71, -v124
    s_cmp_lg_u32 s3, 0
    s_cbranch_scc1 ECXR
    s_waitcnt vmcnt(0)
ECHKR:
    s_mov_b64 s[84:85], 0
    s_cmp_le_u32 s97, 0
    s_cbranch_scc1 EC2R
    v_cmp_eq_u32 vcc, -1, v200
    s_or_b64 s[84:85], s[84:85], vcc
    v_cmp_eq_u32 vcc, -1, v201
    s_or_b64 s[84:85], s[84:85], vcc
    s_cmp_le_u32 s97, 1
    s_cbranch_scc1 EC2R
    v_cmp_eq_u32 vcc, -1, v202
    s_or_b64 s[84:85], s[84:85], vcc
    v_cmp_eq_u32 vcc, -1, v203
    s_or_b64 s[84:85], s[84:85], vcc
    s_cmp_le_u32 s97, 2
    s_cbranch_scc1 EC2R
    v_cmp_eq_u32 vcc, -1, v204
    s_or_b64 s[84:85], s[84:85], vcc
    v_cmp_eq_u32 vcc, -1, v205
    s_or_b64 s[84:85], s[84:85], vcc
    s_cmp_le_u32 s97, 3
    s_cbranch_scc1 EC2R
    v_cmp_eq_u32 vcc, -1, v206
    s_or_b64 s[84:85], s[84:85], vcc
    v_cmp_eq_u32 vcc, -1, v207
    s_or_b64 s[84:85], s[84:85], vcc
    s_cmp_le_u32 s97, 4
    s_cbranch_scc1 EC2R
    v_cmp_eq_u32 vcc, -1, v208
    s_or_b64 s[84:85], s[84:85], vcc
    v_cmp_eq_u32 vcc, -1, v209
    s_or_b64 s[84:85], s[84:85], vcc
    s_cmp_le_u32 s97, 5
    s_cbranch_scc1 EC2R
    v_cmp_eq_u32 vcc, -1, v210
    s_or_b64 s[84:85], s[84:85], vcc
    v_cmp_eq_u32 vcc, -1, v211
    s_or_b64 s[84:85], s[84:85], vcc
    s_cmp_le_u32 s97, 6
    s_cbranch_scc1 EC2R
    v_cmp_eq_u32 vcc, -1, v212
    s_or_b64 s[84:85], s[84:85], vcc
    v_cmp_eq_u32 vcc, -1, v213
    s_or_b64 s[84:85], s[84:85], vcc
    s_cmp_le_u32 s97, 7
    s_cbranch_scc1 EC2R
    v_cmp_eq_u32 vcc, -1, v214
    s_or_b64 s[84:85], s[84:85], vcc
    v_cmp_eq_u32 vcc, -1, v215
    s_or_b64 s[84:85], s[84:85], vcc
    s_cmp_le_u32 s97, 8
    s_cbranch_scc1 EC2R
    v_cmp_eq_u32 vcc, -1, v216
    s_or_b64 s[84:85], s[84:85], vcc
    v_cmp_eq_u32 vcc, -1, v217
    s_or_b64 s[84:85], s[84:85], vcc
    s_cmp_le_u32 s97, 9
    s_cbranch_scc1 EC2R
    v_cmp_eq_u32 vcc, -1, v218
    s_or_b64 s[84:85], s[84:85], vcc
    v_cmp_eq_u32 vcc, -1, v219
    s_or_b64 s[84:85], s[84:85], vcc
    s_cmp_le_u32 s97, 10
    s_cbranch_scc1 EC2R
    v_cmp_eq_u32 vcc, -1, v220
    s_or_b64 s[84:85], s[84:85], vcc
    v_cmp_eq_u32 vcc, -1, v221
    s_or_b64 s[84:85], s[84:85], vcc
    s_cmp_le_u32 s97, 11
    s_cbranch_scc1 EC2R
    v_cmp_eq_u32 vcc, -1, v222
    s_or_b64 s[84:85], s[84:85], vcc
    v_cmp_eq_u32 vcc, -1, v223
    s_or_b64 s[84:85], s[84:85], vcc
    s_cmp_le_u32 s97, 12
    s_cbranch_scc1 EC2R
    v_cmp_eq_u32 vcc, -1, v224
    s_or_b64 s[84:85], s[84:85], vcc
    v_cmp_eq_u32 vcc, -1, v225
    s_or_b64 s[84:85], s[84:85], vcc
    s_cmp_le_u32 s97, 13
    s_cbranch_scc1 EC2R
    v_cmp_eq_u32 vcc, -1, v226
    s_or_b64 s[84:85], s[84:85], vcc
    v_cmp_eq_u32 vcc, -1, v227
    s_or_b64 s[84:85], s[84:85], vcc
    s_cmp_le_u32 s97, 14
    s_cbranch_scc1 EC2R
    v_cmp_eq_u32 vcc, -1, v228
    s_or_b64 s[84:85], s[84:85], vcc
    v_cmp_eq_u32 vcc, -1, v229
    s_or_b64 s[84:85], s[84:85], vcc
EC2R:
    s_cmp_eq_u64 s[84:85], 0
    s_cbranch_scc1 EOKR
    s_cmp_eq_u32 s96, 0
    s_cbranch_scc1 EOKR
    s_sub_u32 s96, s96, 1
    s_sleep 1
    s_cmp_le_u32 s97, 0
    s_cbranch_scc1 ELR_1
    s_mov_b32 s84, 12582912
    buffer_load_dwordx2 v[200:201], v248, s[16:19], s84 offen sc1
    s_cmp_le_u32 s97, 1
    s_cbranch_scc1 ELR_1
    s_mov_b32 s84, 12587008
    buffer_load_dwordx2 v[202:203], v248, s[16:19], s84 offen sc1
    s_cmp_le_u32 s97, 2
    s_cbranch_scc1 ELR_1
    s_mov_b32 s84, 12591104
    buffer_load_dwordx2 v[204:205], v248, s[16:19], s84 offen sc1
    s_cmp_le_u32 s97, 3
    s_cbranch_scc1 ELR_1
    s_mov_b32 s84, 12595200
    buffer_load_dwordx2 v[206:207], v248, s[16:19], s84 offen sc1
    s_cmp_le_u32 s97, 4
    s_cbranch_scc1 ELR_1
    s_mov_b32 s84, 12599296
    buffer_load_dwordx2 v[208:209], v248, s[16:19], s84 offen sc1
    s_cmp_le_u32 s97, 5
    s_cbranch_scc1 ELR_1
    s_mov_b32 s84, 12603392
    buffer_load_dwordx2 v[210:211], v248, s[16:19], s84 offen sc1
    s_cmp_le_u32 s97, 6
    s_cbranch_scc1 ELR_1
    s_mov_b32 s84, 12607488
    buffer_load_dwordx2 v[212:213], v248, s[16:19], s84 offen sc1
    s_cmp_le_u32 s97, 7
    s_cbranch_scc1 ELR_1
    s_mov_b32 s84, 12611584
    buffer_load_dwordx2 v[214:215], v248, s[16:19], s84 offen sc1
    s_cmp_le_u32 s97, 8
    s_cbranch_scc1 ELR_1
    s_mov_b32 s84, 12615680
    buffer_load_dwordx2 v[216:217], v248, s[16:19], s84 offen sc1
    s_cmp_le_u32 s97, 9
    s_cbranch_scc1 ELR_1
    s_mov_b32 s84, 12619776
    buffer_load_dwordx2 v[218:219], v248, s[16:19], s84 offen sc1
    s_cmp_le_u32 s97, 10
    s_cbranch_scc1 ELR_1
    s_mov_b32 s84, 12623872
    buffer_load_dwordx2 v[220:221], v248, s[16:19], s84 offen sc1
    s_cmp_le_u32 s97, 11
    s_cbranch_scc1 ELR_1
    s_mov_b32 s84, 12627968
    buffer_load_dwordx2 v[222:223], v248, s[16:19], s84 offen sc1
    s_cmp_le_u32 s97, 12
    s_cbranch_scc1 ELR_1
    s_mov_b32 s84, 12632064
    buffer_load_dwordx2 v[224:225], v248, s[16:19], s84 offen sc1
    s_cmp_le_u32 s97, 13
    s_cbranch_scc1 ELR_1
    s_mov_b32 s84, 12636160
    buffer_load_dwordx2 v[226:227], v248, s[16:19], s84 offen sc1
    s_cmp_le_u32 s97, 14
    s_cbranch_scc1 ELR_1
    s_mov_b32 s84, 12640256
    buffer_load_dwordx2 v[228:229], v248, s[16:19], s84 offen sc1
    ELR_1:
    s_waitcnt vmcnt(0)
    s_branch ECHKR
EOKR:
    v_mov_b32 v240, 0
    v_mov_b32 v241, 0
    s_cmp_le_u32 s97, 0
    s_cbranch_scc1 CLR
    v_pk_fma_f32 v[200:201], v[238:239], v[240:241], v[200:201] op_sel_hi:[0,1,1]
    v_pk_fma_f32 v[240:241], v[238:239], v[240:241], v[200:201] op_sel:[1,1,0] op_sel_hi:[1,0,1] neg_lo:[1,0,0]
    s_cmp_le_u32 s97, 1
    s_cbranch_scc1 CLR
    v_pk_fma_f32 v[202:203], v[238:239], v[240:241], v[202:203] op_sel_hi:[0,1,1]
    v_pk_fma_f32 v[240:241], v[238:239], v[240:241], v[202:203] op_sel:[1,1,0] op_sel_hi:[1,0,1] neg_lo:[1,0,0]
    s_cmp_le_u32 s97, 2
    s_cbranch_scc1 CLR
    v_pk_fma_f32 v[204:205], v[238:239], v[240:241], v[204:205] op_sel_hi:[0,1,1]
    v_pk_fma_f32 v[240:241], v[238:239], v[240:241], v[204:205] op_sel:[1,1,0] op_sel_hi:[1,0,1] neg_lo:[1,0,0]
    s_cmp_le_u32 s97, 3
    s_cbranch_scc1 CLR
    v_pk_fma_f32 v[206:207], v[238:239], v[240:241], v[206:207] op_sel_hi:[0,1,1]
    v_pk_fma_f32 v[240:241], v[238:239], v[240:241], v[206:207] op_sel:[1,1,0] op_sel_hi:[1,0,1] neg_lo:[1,0,0]
    s_cmp_le_u32 s97, 4
    s_cbranch_scc1 CLR
    v_pk_fma_f32 v[208:209], v[238:239], v[240:241], v[208:209] op_sel_hi:[0,1,1]
    v_pk_fma_f32 v[240:241], v[238:239], v[240:241], v[208:209] op_sel:[1,1,0] op_sel_hi:[1,0,1] neg_lo:[1,0,0]
    s_cmp_le_u32 s97, 5
    s_cbranch_scc1 CLR
    v_pk_fma_f32 v[210:211], v[238:239], v[240:241], v[210:211] op_sel_hi:[0,1,1]
    v_pk_fma_f32 v[240:241], v[238:239], v[240:241], v[210:211] op_sel:[1,1,0] op_sel_hi:[1,0,1] neg_lo:[1,0,0]
    s_cmp_le_u32 s97, 6
    s_cbranch_scc1 CLR
    v_pk_fma_f32 v[212:213], v[238:239], v[240:241], v[212:213] op_sel_hi:[0,1,1]
    v_pk_fma_f32 v[240:241], v[238:239], v[240:241], v[212:213] op_sel:[1,1,0] op_sel_hi:[1,0,1] neg_lo:[1,0,0]
    s_cmp_le_u32 s97, 7
    s_cbranch_scc1 CLR
    v_pk_fma_f32 v[214:215], v[238:239], v[240:241], v[214:215] op_sel_hi:[0,1,1]
    v_pk_fma_f32 v[240:241], v[238:239], v[240:241], v[214:215] op_sel:[1,1,0] op_sel_hi:[1,0,1] neg_lo:[1,0,0]
    s_cmp_le_u32 s97, 8
    s_cbranch_scc1 CLR
    v_pk_fma_f32 v[216:217], v[238:239], v[240:241], v[216:217] op_sel_hi:[0,1,1]
    v_pk_fma_f32 v[240:241], v[238:239], v[240:241], v[216:217] op_sel:[1,1,0] op_sel_hi:[1,0,1] neg_lo:[1,0,0]
    s_cmp_le_u32 s97, 9
    s_cbranch_scc1 CLR
    v_pk_fma_f32 v[218:219], v[238:239], v[240:241], v[218:219] op_sel_hi:[0,1,1]
    v_pk_fma_f32 v[240:241], v[238:239], v[240:241], v[218:219] op_sel:[1,1,0] op_sel_hi:[1,0,1] neg_lo:[1,0,0]
    s_cmp_le_u32 s97, 10
    s_cbranch_scc1 CLR
    v_pk_fma_f32 v[220:221], v[238:239], v[240:241], v[220:221] op_sel_hi:[0,1,1]
    v_pk_fma_f32 v[240:241], v[238:239], v[240:241], v[220:221] op_sel:[1,1,0] op_sel_hi:[1,0,1] neg_lo:[1,0,0]
    s_cmp_le_u32 s97, 11
    s_cbranch_scc1 CLR
    v_pk_fma_f32 v[222:223], v[238:239], v[240:241], v[222:223] op_sel_hi:[0,1,1]
    v_pk_fma_f32 v[240:241], v[238:239], v[240:241], v[222:223] op_sel:[1,1,0] op_sel_hi:[1,0,1] neg_lo:[1,0,0]
    s_cmp_le_u32 s97, 12
    s_cbranch_scc1 CLR
    v_pk_fma_f32 v[224:225], v[238:239], v[240:241], v[224:225] op_sel_hi:[0,1,1]
    v_pk_fma_f32 v[240:241], v[238:239], v[240:241], v[224:225] op_sel:[1,1,0] op_sel_hi:[1,0,1] neg_lo:[1,0,0]
    s_cmp_le_u32 s97, 13
    s_cbranch_scc1 CLR
    v_pk_fma_f32 v[226:227], v[238:239], v[240:241], v[226:227] op_sel_hi:[0,1,1]
    v_pk_fma_f32 v[240:241], v[238:239], v[240:241], v[226:227] op_sel:[1,1,0] op_sel_hi:[1,0,1] neg_lo:[1,0,0]
    s_cmp_le_u32 s97, 14
    s_cbranch_scc1 CLR
    v_pk_fma_f32 v[228:229], v[238:239], v[240:241], v[228:229] op_sel_hi:[0,1,1]
    v_pk_fma_f32 v[240:241], v[238:239], v[240:241], v[228:229] op_sel:[1,1,0] op_sel_hi:[1,0,1] neg_lo:[1,0,0]
CLR:
    ds_write_b64 v247, v[240:241]
ECXR:
    s_waitcnt lgkmcnt(0)
    s_barrier
    ds_read_b64 v[240:241], v247
    s_waitcnt lgkmcnt(0)
    v_fma_f32 v118, v194, v240, v110
    v_fma_f32 v119, v194, v241, v111
    v_fma_f32 v118, -v195, v241, v118
    v_fma_f32 v119, v195, v240, v119
    v_fma_f32 v120, v194, v118, v112
    v_fma_f32 v121, v194, v119, v113
    v_fma_f32 v120, -v195, v119, v120
    v_fma_f32 v121, v195, v118, v121
    v_fma_f32 v122, v194, v120, v114
    v_fma_f32 v123, v194, v121, v115
    v_fma_f32 v122, -v195, v121, v122
    v_fma_f32 v123, v195, v120, v123
    v_mov_b32 v88, v240
    v_mov_b32 v97, v241
    s_cmp_eq_u32 s3, 1
    s_cselect_b64 vcc, -1, 0
    v_cndmask_b32 v88, v88, v118, vcc
    v_cndmask_b32 v97, v97, v119, vcc
    s_cmp_eq_u32 s3, 2
    s_cselect_b64 vcc, -1, 0
    v_cndmask_b32 v88, v88, v120, vcc
    v_cndmask_b32 v97, v97, v121, vcc
    s_cmp_eq_u32 s3, 3
    s_cselect_b64 vcc, -1, 0
    v_cndmask_b32 v88, v88, v122, vcc
    v_cndmask_b32 v97, v97, v123, vcc
    v_fma_f32 v89, v190, v88, v72
    v_fma_f32 v98, v190, v97, v76
    v_fma_f32 v89, -v191, v97, v89
    v_fma_f32 v98, v191, v88, v98
    v_fma_f32 v90, v190, v89, v80
    v_fma_f32 v99, v190, v98, v84
    v_fma_f32 v90, -v191, v98, v90
    v_fma_f32 v99, v191, v89, v99
    v_fma_f32 v91, v190, v90, v73
    v_fma_f32 v100, v190, v99, v77
    v_fma_f32 v91, -v191, v99, v91
    v_fma_f32 v100, v191, v90, v100
    v_fma_f32 v92, v190, v91, v81
    v_fma_f32 v101, v190, v100, v85
    v_fma_f32 v92, -v191, v100, v92
    v_fma_f32 v101, v191, v91, v101
    v_fma_f32 v93, v190, v92, v74
    v_fma_f32 v102, v190, v101, v78
    v_fma_f32 v93, -v191, v101, v93
    v_fma_f32 v102, v191, v92, v102
    v_fma_f32 v94, v190, v93, v82
    v_fma_f32 v103, v190, v102, v86
    v_fma_f32 v94, -v191, v102, v94
    v_fma_f32 v103, v191, v93, v103
    v_fma_f32 v95, v190, v94, v75
    v_fma_f32 v104, v190, v103, v79
    v_fma_f32 v95, -v191, v103, v95
    v_fma_f32 v104, v191, v94, v104
    v_cmp_lt_u32 vcc, 31, v1
    s_nop 0
    v_cndmask_b32 v114, v88, v89, vcc
    v_cndmask_b32 v118, v97, v98, vcc
    v_cndmask_b32 v115, v90, v91, vcc
    v_cndmask_b32 v119, v99, v100, vcc
    v_cndmask_b32 v116, v92, v93, vcc
    v_cndmask_b32 v120, v101, v102, vcc
    v_cndmask_b32 v117, v94, v95, vcc
    v_cndmask_b32 v121, v103, v104, vcc
    v_mul_f32 v106, v234, v114
    v_mul_f32 v110, v234, v118
    v_fma_f32 v106, -v235, v118, v106
    v_fma_f32 v110, v235, v114, v110
    v_mul_f32 v107, v234, v115
    v_mul_f32 v111, v234, v119
    v_fma_f32 v107, -v235, v119, v107
    v_fma_f32 v111, v235, v115, v111
    v_mul_f32 v108, v234, v116
    v_mul_f32 v112, v234, v120
    v_fma_f32 v108, -v235, v120, v108
    v_fma_f32 v112, v235, v116, v112
    v_mul_f32 v109, v234, v117
    v_mul_f32 v113, v234, v121
    v_fma_f32 v109, -v235, v121, v109
    v_fma_f32 v113, v235, v117, v113
    v_fma_f32 v40, v184, v106, v40
    v_fma_f32 v56, -v184, v110, v56
    v_fma_f32 v40, -v185, v110, v40
    v_fma_f32 v56, -v185, v106, v56
    v_cvt_pk_bf16_f32 v40, v40, v56
    ds_write_b16 v232, v40 offset:0
    ds_write_b16_d16_hi v249, v40 offset:0
    v_fma_f32 v41, v186, v106, v41
    v_fma_f32 v57, -v186, v110, v57
    v_fma_f32 v41, -v187, v110, v41
    v_fma_f32 v57, -v187, v106, v57
    v_cvt_pk_bf16_f32 v41, v41, v57
    ds_write_b16 v232, v41 offset:128
    ds_write_b16_d16_hi v249, v41 offset:128
    v_fma_f32 v42, v188, v106, v42
    v_fma_f32 v58, -v188, v110, v58
    v_fma_f32 v42, -v189, v110, v42
    v_fma_f32 v58, -v189, v106, v58
    v_cvt_pk_bf16_f32 v42, v42, v58
    ds_write_b16 v232, v42 offset:256
    ds_write_b16_d16_hi v249, v42 offset:256
    v_fma_f32 v43, v190, v106, v43
    v_fma_f32 v59, -v190, v110, v59
    v_fma_f32 v43, -v191, v110, v43
    v_fma_f32 v59, -v191, v106, v59
    v_cvt_pk_bf16_f32 v43, v43, v59
    ds_write_b16 v232, v43 offset:384
    ds_write_b16_d16_hi v249, v43 offset:384
    v_fma_f32 v44, v184, v107, v44
    v_fma_f32 v60, -v184, v111, v60
    v_fma_f32 v44, -v185, v111, v44
    v_fma_f32 v60, -v185, v107, v60
    v_cvt_pk_bf16_f32 v44, v44, v60
    ds_write_b16 v232, v44 offset:1024
    ds_write_b16_d16_hi v249, v44 offset:1024
    v_fma_f32 v45, v186, v107, v45
    v_fma_f32 v61, -v186, v111, v61
    v_fma_f32 v45, -v187, v111, v45
    v_fma_f32 v61, -v187, v107, v61
    v_cvt_pk_bf16_f32 v45, v45, v61
    ds_write_b16 v232, v45 offset:1152
    ds_write_b16_d16_hi v249, v45 offset:1152
    v_fma_f32 v46, v188, v107, v46
    v_fma_f32 v62, -v188, v111, v62
    v_fma_f32 v46, -v189, v111, v46
    v_fma_f32 v62, -v189, v107, v62
    v_cvt_pk_bf16_f32 v46, v46, v62
    ds_write_b16 v232, v46 offset:1280
    ds_write_b16_d16_hi v249, v46 offset:1280
    v_fma_f32 v47, v190, v107, v47
    v_fma_f32 v63, -v190, v111, v63
    v_fma_f32 v47, -v191, v111, v47
    v_fma_f32 v63, -v191, v107, v63
    v_cvt_pk_bf16_f32 v47, v47, v63
    ds_write_b16 v232, v47 offset:1408
    ds_write_b16_d16_hi v249, v47 offset:1408
    v_fma_f32 v48, v184, v108, v48
    v_fma_f32 v64, -v184, v112, v64
    v_fma_f32 v48, -v185, v112, v48
    v_fma_f32 v64, -v185, v108, v64
    v_cvt_pk_bf16_f32 v48, v48, v64
    ds_write_b16 v232, v48 offset:2048
    ds_write_b16_d16_hi v249, v48 offset:2048
    v_fma_f32 v49, v186, v108, v49
    v_fma_f32 v65, -v186, v112, v65
    v_fma_f32 v49, -v187, v112, v49
    v_fma_f32 v65, -v187, v108, v65
    v_cvt_pk_bf16_f32 v49, v49, v65
    ds_write_b16 v232, v49 offset:2176
    ds_write_b16_d16_hi v249, v49 offset:2176
    v_fma_f32 v50, v188, v108, v50
    v_fma_f32 v66, -v188, v112, v66
    v_fma_f32 v50, -v189, v112, v50
    v_fma_f32 v66, -v189, v108, v66
    v_cvt_pk_bf16_f32 v50, v50, v66
    ds_write_b16 v232, v50 offset:2304
    ds_write_b16_d16_hi v249, v50 offset:2304
    v_fma_f32 v51, v190, v108, v51
    v_fma_f32 v67, -v190, v112, v67
    v_fma_f32 v51, -v191, v112, v51
    v_fma_f32 v67, -v191, v108, v67
    v_cvt_pk_bf16_f32 v51, v51, v67
    ds_write_b16 v232, v51 offset:2432
    ds_write_b16_d16_hi v249, v51 offset:2432
    v_fma_f32 v52, v184, v109, v52
    v_fma_f32 v68, -v184, v113, v68
    v_fma_f32 v52, -v185, v113, v52
    v_fma_f32 v68, -v185, v109, v68
    v_cvt_pk_bf16_f32 v52, v52, v68
    ds_write_b16 v232, v52 offset:3072
    ds_write_b16_d16_hi v249, v52 offset:3072
    v_fma_f32 v53, v186, v109, v53
    v_fma_f32 v69, -v186, v113, v69
    v_fma_f32 v53, -v187, v113, v53
    v_fma_f32 v69, -v187, v109, v69
    v_cvt_pk_bf16_f32 v53, v53, v69
    ds_write_b16 v232, v53 offset:3200
    ds_write_b16_d16_hi v249, v53 offset:3200
    v_fma_f32 v54, v188, v109, v54
    v_fma_f32 v70, -v188, v113, v70
    v_fma_f32 v54, -v189, v113, v54
    v_fma_f32 v70, -v189, v109, v70
    v_cvt_pk_bf16_f32 v54, v54, v70
    ds_write_b16 v232, v54 offset:3328
    ds_write_b16_d16_hi v249, v54 offset:3328
    v_fma_f32 v55, v190, v109, v55
    v_fma_f32 v71, -v190, v113, v71
    v_fma_f32 v55, -v191, v113, v55
    v_fma_f32 v71, -v191, v109, v71
    v_cvt_pk_bf16_f32 v55, v55, v71
    ds_write_b16 v232, v55 offset:3456
    ds_write_b16_d16_hi v249, v55 offset:3456
    s_waitcnt lgkmcnt(0)
    ds_read_b128 v[72:75], v233 offset:0
    ds_read_b128 v[76:79], v233 offset:1024
    ds_read_b128 v[80:83], v233 offset:2048
    ds_read_b128 v[84:87], v233 offset:3072
    s_waitcnt lgkmcnt(0)
    s_add_u32 s84, s98, 0
    buffer_store_dwordx4 v[72:75], v242, s[16:19], s84 offen sc1
    s_add_u32 s84, s98, 16384
    buffer_store_dwordx4 v[76:79], v242, s[16:19], s84 offen sc1
    s_add_u32 s84, s98, 32768
    buffer_store_dwordx4 v[80:83], v242, s[16:19], s84 offen sc1
    s_add_u32 s84, s98, 49152
    buffer_store_dwordx4 v[84:87], v242, s[16:19], s84 offen sc1
    s_waitcnt vmcnt(0)
    s_barrier
    s_cmp_lg_u32 s3, 0
    s_cbranch_scc1 R_HBFL
    s_mov_b64 exec, 1
    buffer_store_dword v250, v243, s[16:19], s99 offen sc1
    s_mov_b64 exec, -1
    R_HBFL:
    s_mov_b32 s20, s46
    s_and_b32 s21, s47, 0xffff
    s_mov_b32 s22, 0x80000
    s_mov_b32 s23, 0x00020000
    s_mov_b32 s24, s48
    s_and_b32 s25, s49, 0xffff
    s_mov_b32 s26, 0x80000
    s_mov_b32 s27, 0x00020000
    s_mov_b32 s28, s60
    s_and_b32 s29, s61, 0xffff
    s_mov_b32 s30, 0x560000
    s_mov_b32 s31, 0x00020000
    s_sub_u32 s74, s73, 22
    s_lshl_b32 s74, s74, 8
    v_add_u32 v4, s74, v0
    v_lshlrev_b32 v5, 7, v4
    buffer_load_dword v231, v5, s[20:23], 0 offen
    buffer_load_dword v231, v5, s[24:27], 0 offen
    v_add_u32 v6, 327680, v5
    buffer_load_dword v231, v6, s[20:23], 0 offen
    buffer_load_dword v231, v6, s[24:27], 0 offen
    v_lshrrev_b32 v5, 2, v4
    v_lshlrev_b32 v5, 12, v5
    v_and_b32 v6, 3, v4
    v_lshl_add_u32 v5, v6, 7, v5
    s_lshl_b32 s75, s72, 9
    v_add_u32 v5, s75, v5
    v_add_u32 v6, 2621440, v5
    v_add_u32 v7, 5242880, v5
    buffer_load_dword v231, v5, s[28:31], 0 offen
    buffer_load_dword v231, v6, s[28:31], 0 offen
    buffer_load_dword v231, v7, s[28:31], 0 offen
    s_and_b32 s72, s2, 7
    s_lshr_b32 s73, s2, 3
    s_lshr_b32 s74, s73, 3
    s_lshl_b32 s72, s72, 2
    s_add_u32 s72, s72, s74
    s_and_b32 s73, s73, 7
    s_lshr_b32 s86, s72, 1
    s_lshl_b32 s86, s86, 7
    s_add_u32 s97, s86, 13647872
    v_and_b32 v4, 15, v1
    v_lshlrev_b32 v226, 2, v4
    v_min_u32 v4, 21, v1
    v_lshlrev_b32 v228, 2, v4
    s_and_b32 s98, s72, 7
    s_lshl_b32 s98, s98, 3
    s_add_u32 s98, s98, s73
    s_lshl_b32 s98, s98, 7
    s_add_u32 s98, s98, 13664256
    s_lshl_b32 s74, s72, 6
    s_lshl_b32 s75, s73, 6
    s_lshr_b32 s76, s3, 1
    s_and_b32 s77, s3, 1
    v_and_b32 v3, 31, v1
    s_lshl_b32 s78, s77, 5
    s_add_u32 s78, s78, s74
    v_add_u32 v3, s78, v3
    v_lshrrev_b32 v176, 3, v3
    v_lshlrev_b32 v176, 7, v176
    v_and_b32 v4, 7, v3
    v_lshl_add_u32 v176, v4, 2, v176
    v_lshlrev_b32 v177, 1, v3
    s_lshl_b32 s79, s76, 5
    s_add_u32 s79, s79, s75
    v_lshrrev_b32 v4, 5, v1
    v_lshlrev_b32 v4, 2, v4
    v_add_u32 v4, s79, v4
    v_lshlrev_b32 v178, 1, v4
    v_lshl_add_u32 v179, v3, 10, v178
    v_lshlrev_b32 v198, 1, v179
    v_lshrrev_b32 v4, 2, v1
    v_add_u32 v4, s78, v4
    v_lshlrev_b32 v4, 10, v4
    v_and_b32 v5, 3, v1
    v_lshl_add_u32 v4, v5, 4, v4
    s_lshl_b32 s80, s79, 1
    v_add_u32 v179, s80, v4
    v_lshrrev_b32 v4, 3, v1
    v_lshrrev_b32 v5, 4, v1
    v_and_b32 v6, 7, v1
    v_add_u32 v7, s78, v4
    v_lshlrev_b32 v7, 11, v7
    v_lshl_add_u32 v7, v6, 4, v7
    s_lshl_b32 s80, s79, 2
    v_add_u32 v198, s80, v7
    s_lshl_b32 s80, s3, 4
    s_add_u32 s81, s80, s75
    s_add_u32 s82, s80, s74
    s_mov_b32 s86, 1024
    s_mov_b32 s87, 0
    v_add_u32 v7, 0, v5
    v_and_b32 v7, 7, v7
    v_xor_b32 v7, v7, v6
    v_lshlrev_b32 v7, 4, v7
    v_add_u32 v200, s81, v4
    v_mul_lo_u32 v200, v200, s86
    v_add_u32 v200, v200, v7
    v_add_u32 v200, s87, v200
    v_add_u32 v7, 4, v5
    v_and_b32 v7, 7, v7
    v_xor_b32 v7, v7, v6
    v_lshlrev_b32 v7, 4, v7
    v_add_u32 v201, s81, v4
    v_add_u32 v201, 8, v201
    v_mul_lo_u32 v201, v201, s86
    v_add_u32 v201, v201, v7
    v_add_u32 v201, s87, v201
    v_subrev_u32 v201, 1024, v201
    s_mov_b32 s86, 2048
    s_mov_b32 s87, 16777216
    v_add_u32 v7, 0, v5
    v_and_b32 v7, 7, v7
    v_xor_b32 v7, v7, v6
    v_and_b32 v202, 4, v7
    v_add_u32 v7, v7, v202
    v_lshlrev_b32 v7, 4, v7
    v_add_u32 v202, s82, v4
    v_mul_lo_u32 v202, v202, s86
    v_add_u32 v202, v202, v7
    v_add_u32 v202, s87, v202
    v_add_u32 v7, 4, v5
    v_and_b32 v7, 7, v7
    v_xor_b32 v7, v7, v6
    v_and_b32 v203, 4, v7
    v_add_u32 v7, v7, v203
    v_lshlrev_b32 v7, 4, v7
    v_add_u32 v203, s82, v4
    v_add_u32 v203, 8, v203
    v_mul_lo_u32 v203, v203, s86
    v_add_u32 v203, v203, v7
    v_add_u32 v203, s87, v203
    v_subrev_u32 v203, 1024, v203
    s_and_b32 s86, s73, 3
    s_lshl_b32 s86, s86, 4
    s_add_u32 s86, s86, s74
    s_lshl_b32 s86, s86, 11
    s_add_u32 s86, s86, s87
    v_lshlrev_b32 v230, 7, v0
    v_add_u32 v230, s86, v230
    s_mov_b32 s86, 2816
    s_mov_b32 s87, 20971520
    v_add_u32 v7, 0, v5
    v_and_b32 v7, 7, v7
    v_xor_b32 v7, v7, v6
    v_lshlrev_b32 v7, 4, v7
    v_add_u32 v204, s81, v4
    v_mul_lo_u32 v204, v204, s86
    v_add_u32 v204, v204, v7
    v_add_u32 v204, s87, v204
    v_add_u32 v7, 4, v5
    v_and_b32 v7, 7, v7
    v_xor_b32 v7, v7, v6
    v_lshlrev_b32 v7, 4, v7
    v_add_u32 v205, s81, v4
    v_add_u32 v205, 8, v205
    v_mul_lo_u32 v205, v205, s86
    v_add_u32 v205, v205, v7
    v_add_u32 v205, s87, v205
    v_subrev_u32 v205, 1024, v205
    s_mov_b32 s86, 4096
    s_lshl_b32 s87, s74, 1
    v_and_b32 v7, 1, v5
    v_lshlrev_b32 v7, 2, v7
    v_xor_b32 v7, v7, v6
    v_lshlrev_b32 v7, 4, v7
    v_add_u32 v206, s80, v4
    v_mul_lo_u32 v206, v206, s86
    v_add_u32 v206, v206, v7
    v_add_u32 v206, s87, v206
    v_and_b32 v7, 1, v5
    v_lshlrev_b32 v7, 2, v7
    v_xor_b32 v7, v7, v6
    v_lshlrev_b32 v7, 4, v7
    v_add_u32 v207, s80, v4
    v_add_u32 v207, 8, v207
    v_mul_lo_u32 v207, v207, s86
    v_add_u32 v207, v207, v7
    v_add_u32 v207, s87, v207
    v_subrev_u32 v207, 1024, v207
    s_lshl_b32 s86, s76, 12
    s_lshl_b32 s87, s77, 12
    s_lshl_b32 s88, s77, 2
    v_and_b32 v113, 31, v1
    v_lshrrev_b32 v114, 1, v113
    v_and_b32 v114, 7, v114
    v_lshrrev_b32 v180, 5, v1
    v_xor_b32 v114, v114, v180
    v_lshlrev_b32 v114, 4, v114
    v_lshl_add_u32 v114, v113, 7, v114
    v_add_u32 v114, s86, v114
    v_xor_b32 v180, 0, v114
    v_add_u32 v184, 65536, v180
    v_xor_b32 v181, 32, v114
    v_add_u32 v185, 65536, v181
    v_xor_b32 v182, 64, v114
    v_add_u32 v186, 65536, v182
    v_xor_b32 v183, 96, v114
    v_add_u32 v187, 65536, v183
    v_and_b32 v113, 31, v1
    v_lshrrev_b32 v114, 1, v113
    v_and_b32 v114, 7, v114
    v_lshrrev_b32 v188, 5, v1
    v_xor_b32 v114, v114, v188
    v_lshlrev_b32 v114, 4, v114
    v_lshl_add_u32 v114, v113, 7, v114
    v_add_u32 v114, s87, v114
    v_add_u32 v114, 8192, v114
    v_xor_b32 v188, 0, v114
    v_add_u32 v192, 65536, v188
    v_xor_b32 v189, 32, v114
    v_add_u32 v193, 65536, v189
    v_xor_b32 v190, 64, v114
    v_add_u32 v194, 65536, v190
    v_xor_b32 v191, 96, v114
    v_add_u32 v195, 65536, v191
    v_and_b32 v113, 15, v1
    v_lshrrev_b32 v114, 4, v1
    v_and_b32 v114, 1, v114
    v_lshlrev_b32 v114, 1, v114
    v_bfe_u32 v115, v113, 1, 1
    v_add_u32 v114, v114, v115
    v_add_u32 v114, s88, v114
    v_bfe_u32 v115, v113, 3, 1
    v_lshlrev_b32 v115, 2, v115
    v_xor_b32 v114, v114, v115
    v_lshlrev_b32 v114, 4, v114
    v_and_b32 v115, 1, v113
    v_lshl_add_u32 v114, v115, 3, v114
    v_lshrrev_b32 v115, 2, v113
    v_lshrrev_b32 v113, 5, v1
    v_lshl_add_u32 v115, v113, 3, v115
    v_lshl_add_u32 v196, v115, 7, v114
    v_add_u32 v196, 8192, v196
    v_add_u32 v197, 65536, v196
    s_mov_b32 s20, s46
    s_and_b32 s21, s47, 0xffff
    s_mov_b32 s22, 0x80000
    s_mov_b32 s23, 0x00020000
    s_mov_b32 s24, s48
    s_and_b32 s25, s49, 0xffff
    s_mov_b32 s26, 0x80000
    s_mov_b32 s27, 0x00020000
    s_mov_b32 s28, s60
    s_and_b32 s29, s61, 0xffff
    s_mov_b32 s30, 0x560000
    s_mov_b32 s31, 0x00020000
    s_mov_b32 s32, s66
    s_and_b32 s33, s67, 0xffff
    s_mov_b32 s34, 0x400000
    s_mov_b32 s35, 0x00020000
    buffer_load_dword v227, v226, s[16:19], s97 offen sc1
    s_waitcnt vmcnt(0)
HBCHKR:
    v_cmp_ne_u32 vcc, v250, v227
    s_cbranch_vccz HBOKR
    s_cmp_eq_u32 s96, 0
    s_cbranch_scc1 HBOKR
    s_sub_u32 s96, s96, 1
    s_sleep 1
    buffer_load_dword v227, v226, s[16:19], s97 offen sc1
    s_waitcnt vmcnt(0)
    s_branch HBCHKR
HBOKR:
    s_mov_b32 s84, 0
    s_add_u32 m0, s83, 49152
    s_nop 0
    buffer_load_dwordx4 v200, s[20:23], s84 offen lds
    buffer_load_dwordx4 v201, s[20:23], s84 offen offset:1024 lds
    s_mov_b32 s84, 0
    s_add_u32 m0, s83, 65536
    s_nop 0
    buffer_load_dwordx4 v200, s[24:27], s84 offen lds
    buffer_load_dwordx4 v201, s[24:27], s84 offen offset:1024 lds
    s_mov_b32 s84, 128
    s_add_u32 m0, s83, 81920
    s_nop 0
    buffer_load_dwordx4 v200, s[20:23], s84 offen lds
    buffer_load_dwordx4 v201, s[20:23], s84 offen offset:1024 lds
    s_mov_b32 s84, 128
    s_add_u32 m0, s83, 98304
    s_nop 0
    buffer_load_dwordx4 v200, s[24:27], s84 offen lds
    buffer_load_dwordx4 v201, s[24:27], s84 offen offset:1024 lds
    s_mov_b32 s85, 0
    s_add_u32 m0, s83, 57344
    s_nop 0
    buffer_load_dwordx4 v202, s[16:19], s85 offen lds
    buffer_load_dwordx4 v203, s[16:19], s85 offen offset:1024 lds
    s_mov_b32 s85, 64
    s_add_u32 m0, s83, 73728
    s_nop 0
    buffer_load_dwordx4 v202, s[16:19], s85 offen lds
    buffer_load_dwordx4 v203, s[16:19], s85 offen offset:1024 lds
    s_mov_b32 s85, 256
    s_add_u32 m0, s83, 90112
    s_nop 0
    buffer_load_dwordx4 v202, s[16:19], s85 offen lds
    buffer_load_dwordx4 v203, s[16:19], s85 offen offset:1024 lds
    s_mov_b32 s85, 320
    s_add_u32 m0, s83, 106496
    s_nop 0
    buffer_load_dwordx4 v202, s[16:19], s85 offen lds
    buffer_load_dwordx4 v203, s[16:19], s85 offen offset:1024 lds
    s_mov_b32 s84, 256
    s_add_u32 m0, s83, 114688
    s_nop 0
    buffer_load_dwordx4 v200, s[20:23], s84 offen lds
    buffer_load_dwordx4 v201, s[20:23], s84 offen offset:1024 lds
    s_mov_b32 s85, 512
    s_add_u32 m0, s83, 122880
    s_nop 0
    buffer_load_dwordx4 v202, s[16:19], s85 offen lds
    buffer_load_dwordx4 v203, s[16:19], s85 offen offset:1024 lds
    s_mov_b32 s84, 256
    s_add_u32 m0, s83, 0
    s_nop 0
    buffer_load_dwordx4 v200, s[24:27], s84 offen lds
    buffer_load_dwordx4 v201, s[24:27], s84 offen offset:1024 lds
    s_mov_b32 s85, 576
    s_add_u32 m0, s83, 8192
    s_nop 0
    buffer_load_dwordx4 v202, s[16:19], s85 offen lds
    buffer_load_dwordx4 v203, s[16:19], s85 offen offset:1024 lds
    buffer_load_dword v231, v230, s[16:19], 0 offen
    buffer_load_dword v231, v226, s[16:19], s97 offen
    buffer_load_dword v231, v226, s[16:19], s97 offen
    s_branch G32
F_ROLE:
    s_mov_b32 s85, 0
    s_add_u32 m0, s83, 57344
    s_nop 0
    buffer_load_dwordx4 v10, s[16:19], s85 offen lds
    buffer_load_dwordx4 v11, s[16:19], s85 offen offset:1024 lds
    s_mov_b32 s85, 65536
    s_add_u32 m0, s83, 73728
    s_nop 0
    buffer_load_dwordx4 v10, s[16:19], s85 offen lds
    buffer_load_dwordx4 v11, s[16:19], s85 offen offset:1024 lds
    s_mov_b32 s85, 131072
    s_add_u32 m0, s83, 90112
    s_nop 0
    buffer_load_dwordx4 v10, s[16:19], s85 offen lds
    buffer_load_dwordx4 v11, s[16:19], s85 offen offset:1024 lds
    s_mov_b32 s85, 196608
    s_add_u32 m0, s83, 106496
    s_nop 0
    buffer_load_dwordx4 v10, s[16:19], s85 offen lds
    buffer_load_dwordx4 v11, s[16:19], s85 offen offset:1024 lds
    s_mov_b32 s85, 262144
    s_add_u32 m0, s83, 122880
    s_nop 0
    buffer_load_dwordx4 v10, s[16:19], s85 offen lds
    buffer_load_dwordx4 v11, s[16:19], s85 offen offset:1024 lds
    s_mov_b32 s85, 327680
    s_add_u32 m0, s83, 8192
    s_nop 0
    buffer_load_dwordx4 v10, s[16:19], s85 offen lds
    buffer_load_dwordx4 v11, s[16:19], s85 offen offset:1024 lds
    s_cmp_lg_u32 s3, 0
    s_cbranch_scc1 ELXF
    s_cmp_le_u32 s97, 0
    s_cbranch_scc1 ELF_2
    s_mov_b32 s84, 12582912
    buffer_load_dwordx2 v[200:201], v248, s[16:19], s84 offen sc1
    s_cmp_le_u32 s97, 1
    s_cbranch_scc1 ELF_2
    s_mov_b32 s84, 12587008
    buffer_load_dwordx2 v[202:203], v248, s[16:19], s84 offen sc1
    s_cmp_le_u32 s97, 2
    s_cbranch_scc1 ELF_2
    s_mov_b32 s84, 12591104
    buffer_load_dwordx2 v[204:205], v248, s[16:19], s84 offen sc1
    s_cmp_le_u32 s97, 3
    s_cbranch_scc1 ELF_2
    s_mov_b32 s84, 12595200
    buffer_load_dwordx2 v[206:207], v248, s[16:19], s84 offen sc1
    s_cmp_le_u32 s97, 4
    s_cbranch_scc1 ELF_2
    s_mov_b32 s84, 12599296
    buffer_load_dwordx2 v[208:209], v248, s[16:19], s84 offen sc1
    s_cmp_le_u32 s97, 5
    s_cbranch_scc1 ELF_2
    s_mov_b32 s84, 12603392
    buffer_load_dwordx2 v[210:211], v248, s[16:19], s84 offen sc1
    s_cmp_le_u32 s97, 6
    s_cbranch_scc1 ELF_2
    s_mov_b32 s84, 12607488
    buffer_load_dwordx2 v[212:213], v248, s[16:19], s84 offen sc1
    s_cmp_le_u32 s97, 7
    s_cbranch_scc1 ELF_2
    s_mov_b32 s84, 12611584
    buffer_load_dwordx2 v[214:215], v248, s[16:19], s84 offen sc1
    s_cmp_le_u32 s97, 8
    s_cbranch_scc1 ELF_2
    s_mov_b32 s84, 12615680
    buffer_load_dwordx2 v[216:217], v248, s[16:19], s84 offen sc1
    s_cmp_le_u32 s97, 9
    s_cbranch_scc1 ELF_2
    s_mov_b32 s84, 12619776
    buffer_load_dwordx2 v[218:219], v248, s[16:19], s84 offen sc1
    s_cmp_le_u32 s97, 10
    s_cbranch_scc1 ELF_2
    s_mov_b32 s84, 12623872
    buffer_load_dwordx2 v[220:221], v248, s[16:19], s84 offen sc1
    s_cmp_le_u32 s97, 11
    s_cbranch_scc1 ELF_2
    s_mov_b32 s84, 12627968
    buffer_load_dwordx2 v[222:223], v248, s[16:19], s84 offen sc1
    s_cmp_le_u32 s97, 12
    s_cbranch_scc1 ELF_2
    s_mov_b32 s84, 12632064
    buffer_load_dwordx2 v[224:225], v248, s[16:19], s84 offen sc1
    s_cmp_le_u32 s97, 13
    s_cbranch_scc1 ELF_2
    s_mov_b32 s84, 12636160
    buffer_load_dwordx2 v[226:227], v248, s[16:19], s84 offen sc1
    s_cmp_le_u32 s97, 14
    s_cbranch_scc1 ELF_2
    s_mov_b32 s84, 12640256
    buffer_load_dwordx2 v[228:229], v248, s[16:19], s84 offen sc1
    ELF_2:
ELXF:
    s_mov_b32 s85, 393216
    s_add_u32 m0, s83, 24576
    s_nop 0
    buffer_load_dwordx4 v10, s[16:19], s85 offen lds
    buffer_load_dwordx4 v11, s[16:19], s85 offen offset:1024 lds
    s_mov_b32 s85, 458752
    s_add_u32 m0, s83, 40960
    s_nop 0
    buffer_load_dwordx4 v10, s[16:19], s85 offen lds
    buffer_load_dwordx4 v11, s[16:19], s85 offen offset:1024 lds
    s_waitcnt vmcnt(14)
    ds_read_b64_tr_b16 a[0:1], v12 offset:49152
    ds_read_b64_tr_b16 a[2:3], v12 offset:49664
    ds_read_b64_tr_b16 a[4:5], v32 offset:49152
    ds_read_b64_tr_b16 a[6:7], v32 offset:49664
    ds_read_b64_tr_b16 a[8:9], v14 offset:49152
    ds_read_b64_tr_b16 a[10:11], v14 offset:49664
    ds_read_b64_tr_b16 a[12:13], v34 offset:49152
    ds_read_b64_tr_b16 a[14:15], v34 offset:49664
    v_mul_f32 v124, v235, v40
    v_mul_f32 v40, v234, v40
    v_fma_f32 v40, -v235, v56, v40
    v_fma_f32 v56, -v234, v56, -v124
    v_mul_f32 v124, v235, v41
    v_mul_f32 v41, v234, v41
    v_fma_f32 v41, -v235, v57, v41
    v_fma_f32 v57, -v234, v57, -v124
    v_mul_f32 v124, v235, v42
    v_mul_f32 v42, v234, v42
    v_fma_f32 v42, -v235, v58, v42
    v_fma_f32 v58, -v234, v58, -v124
    v_mul_f32 v124, v235, v43
    v_mul_f32 v43, v234, v43
    v_fma_f32 v43, -v235, v59, v43
    v_fma_f32 v59, -v234, v59, -v124
    v_mul_f32 v124, v235, v44
    v_mul_f32 v44, v234, v44
    v_fma_f32 v44, -v235, v60, v44
    v_fma_f32 v60, -v234, v60, -v124
    v_mul_f32 v124, v235, v45
    v_mul_f32 v45, v234, v45
    v_fma_f32 v45, -v235, v61, v45
    v_fma_f32 v61, -v234, v61, -v124
    s_waitcnt vmcnt(12)
    ds_read_b64_tr_b16 a[32:33], v13 offset:0
    ds_read_b64_tr_b16 a[34:35], v13 offset:512
    s_waitcnt lgkmcnt(2)
    v_mfma_f32_32x32x16_bf16 a[64:79], a[0:3], a[12:15], 0
    s_mov_b32 s84, 1409024
    s_add_u32 m0, s83, 49152
    s_nop 0
    buffer_load_dwordx4 v8, s[4:7], s84 offen lds
    ds_read_b64_tr_b16 a[36:37], v33 offset:0
    ds_read_b64_tr_b16 a[38:39], v33 offset:512
    v_mfma_f32_32x32x16_bf16 a[80:95], a[4:7], a[8:11], 0
    buffer_load_dwordx4 v9, s[4:7], s84 offen offset:1024 lds
    s_mov_b32 s85, 524288
    s_add_u32 m0, s83, 57344
    s_nop 0
    buffer_load_dwordx4 v10, s[16:19], s85 offen lds
    ds_read_b64_tr_b16 a[40:41], v15 offset:0
    ds_read_b64_tr_b16 a[42:43], v15 offset:512
    v_mfma_f32_32x32x16_bf16 a[96:111], a[4:7], a[12:15], 0
    buffer_load_dwordx4 v11, s[16:19], s85 offen offset:1024 lds
    ds_read_b64_tr_b16 a[44:45], v35 offset:0
    ds_read_b64_tr_b16 a[46:47], v35 offset:512
    v_mfma_f32_32x32x16_bf16 v[16:31], a[0:3], a[8:11], 0
    v_mul_f32 v124, v235, v46
    v_mul_f32 v46, v234, v46
    v_fma_f32 v46, -v235, v62, v46
    v_fma_f32 v62, -v234, v62, -v124
    v_mul_f32 v124, v235, v47
    v_mul_f32 v47, v234, v47
    v_fma_f32 v47, -v235, v63, v47
    v_fma_f32 v63, -v234, v63, -v124
    v_mul_f32 v124, v235, v48
    v_mul_f32 v48, v234, v48
    v_fma_f32 v48, -v235, v64, v48
    v_fma_f32 v64, -v234, v64, -v124
    v_mul_f32 v124, v235, v49
    v_mul_f32 v49, v234, v49
    v_fma_f32 v49, -v235, v65, v49
    v_fma_f32 v65, -v234, v65, -v124
    v_mul_f32 v124, v235, v50
    v_mul_f32 v50, v234, v50
    v_fma_f32 v50, -v235, v66, v50
    v_fma_f32 v66, -v234, v66, -v124
    s_waitcnt vmcnt(14)
    ds_read_b64_tr_b16 a[0:1], v13 offset:16384
    ds_read_b64_tr_b16 a[2:3], v13 offset:16896
    s_waitcnt lgkmcnt(2)
    v_mfma_f32_32x32x16_bf16 a[64:79], a[32:35], a[44:47], a[64:79]
    s_mov_b32 s84, 1585152
    s_add_u32 m0, s83, 65536
    s_nop 0
    buffer_load_dwordx4 v8, s[4:7], s84 offen lds
    ds_read_b64_tr_b16 a[4:5], v33 offset:16384
    ds_read_b64_tr_b16 a[6:7], v33 offset:16896
    v_mfma_f32_32x32x16_bf16 a[80:95], a[36:39], a[40:43], a[80:95]
    buffer_load_dwordx4 v9, s[4:7], s84 offen offset:1024 lds
    s_mov_b32 s85, 589824
    s_add_u32 m0, s83, 73728
    s_nop 0
    buffer_load_dwordx4 v10, s[16:19], s85 offen lds
    ds_read_b64_tr_b16 a[8:9], v15 offset:16384
    ds_read_b64_tr_b16 a[10:11], v15 offset:16896
    v_mfma_f32_32x32x16_bf16 a[96:111], a[36:39], a[44:47], a[96:111]
    buffer_load_dwordx4 v11, s[16:19], s85 offen offset:1024 lds
    ds_read_b64_tr_b16 a[12:13], v35 offset:16384
    ds_read_b64_tr_b16 a[14:15], v35 offset:16896
    v_mfma_f32_32x32x16_bf16 v[16:31], a[32:35], a[40:43], v[16:31]
    v_mul_f32 v124, v235, v51
    v_mul_f32 v51, v234, v51
    v_fma_f32 v51, -v235, v67, v51
    v_fma_f32 v67, -v234, v67, -v124
    v_mul_f32 v124, v235, v52
    v_mul_f32 v52, v234, v52
    v_fma_f32 v52, -v235, v68, v52
    v_fma_f32 v68, -v234, v68, -v124
    v_mul_f32 v124, v235, v53
    v_mul_f32 v53, v234, v53
    v_fma_f32 v53, -v235, v69, v53
    v_fma_f32 v69, -v234, v69, -v124
    v_mul_f32 v124, v235, v54
    v_mul_f32 v54, v234, v54
    v_fma_f32 v54, -v235, v70, v54
    v_fma_f32 v70, -v234, v70, -v124
    v_mul_f32 v124, v235, v55
    v_mul_f32 v55, v234, v55
    v_fma_f32 v55, -v235, v71, v55
    v_fma_f32 v71, -v234, v71, -v124
    s_waitcnt vmcnt(16)
    ds_read_b64_tr_b16 a[32:33], v13 offset:32768
    ds_read_b64_tr_b16 a[34:35], v13 offset:33280
    s_waitcnt lgkmcnt(2)
    v_mfma_f32_32x32x16_bf16 a[64:79], a[0:3], a[12:15], a[64:79]
    s_mov_b32 s84, 1761280
    s_add_u32 m0, s83, 81920
    s_nop 0
    buffer_load_dwordx4 v8, s[4:7], s84 offen lds
    ds_read_b64_tr_b16 a[36:37], v33 offset:32768
    ds_read_b64_tr_b16 a[38:39], v33 offset:33280
    v_mfma_f32_32x32x16_bf16 a[80:95], a[4:7], a[8:11], a[80:95]
    buffer_load_dwordx4 v9, s[4:7], s84 offen offset:1024 lds
    s_mov_b32 s85, 655360
    s_add_u32 m0, s83, 90112
    s_nop 0
    buffer_load_dwordx4 v10, s[16:19], s85 offen lds
    ds_read_b64_tr_b16 a[40:41], v15 offset:32768
    ds_read_b64_tr_b16 a[42:43], v15 offset:33280
    v_mfma_f32_32x32x16_bf16 a[96:111], a[4:7], a[12:15], a[96:111]
    buffer_load_dwordx4 v11, s[16:19], s85 offen offset:1024 lds
    ds_read_b64_tr_b16 a[44:45], v35 offset:32768
    ds_read_b64_tr_b16 a[46:47], v35 offset:33280
    v_mfma_f32_32x32x16_bf16 v[16:31], a[0:3], a[8:11], v[16:31]
    s_waitcnt vmcnt(18)
    ds_read_b64_tr_b16 a[0:1], v13 offset:49152
    ds_read_b64_tr_b16 a[2:3], v13 offset:49664
    s_waitcnt lgkmcnt(2)
    v_mfma_f32_32x32x16_bf16 a[64:79], a[32:35], a[44:47], a[64:79]
    s_mov_b32 s84, 1937408
    s_add_u32 m0, s83, 98304
    s_nop 0
    buffer_load_dwordx4 v8, s[4:7], s84 offen lds
    ds_read_b64_tr_b16 a[4:5], v33 offset:49152
    ds_read_b64_tr_b16 a[6:7], v33 offset:49664
    v_mfma_f32_32x32x16_bf16 a[80:95], a[36:39], a[40:43], a[80:95]
    buffer_load_dwordx4 v9, s[4:7], s84 offen offset:1024 lds
    s_mov_b32 s85, 720896
    s_add_u32 m0, s83, 106496
    s_nop 0
    buffer_load_dwordx4 v10, s[16:19], s85 offen lds
    ds_read_b64_tr_b16 a[8:9], v15 offset:49152
    ds_read_b64_tr_b16 a[10:11], v15 offset:49664
    v_mfma_f32_32x32x16_bf16 a[96:111], a[36:39], a[44:47], a[96:111]
    buffer_load_dwordx4 v11, s[16:19], s85 offen offset:1024 lds
    ds_read_b64_tr_b16 a[12:13], v35 offset:49152
    ds_read_b64_tr_b16 a[14:15], v35 offset:49664
    v_mfma_f32_32x32x16_bf16 v[16:31], a[32:35], a[40:43], v[16:31]
    s_waitcnt vmcnt(20)
    ds_read_b64_tr_b16 a[32:33], v12 offset:0
    ds_read_b64_tr_b16 a[34:35], v12 offset:512
    s_waitcnt lgkmcnt(2)
    v_mfma_f32_32x32x16_bf16 a[64:79], a[0:3], a[12:15], a[64:79]
    s_mov_b32 s84, 2113536
    s_add_u32 m0, s83, 114688
    s_nop 0
    buffer_load_dwordx4 v8, s[4:7], s84 offen lds
    ds_read_b64_tr_b16 a[36:37], v32 offset:0
    ds_read_b64_tr_b16 a[38:39], v32 offset:512
    v_mfma_f32_32x32x16_bf16 a[80:95], a[4:7], a[8:11], a[80:95]
    buffer_load_dwordx4 v9, s[4:7], s84 offen offset:1024 lds
    s_mov_b32 s85, 786432
    s_add_u32 m0, s83, 122880
    s_nop 0
    buffer_load_dwordx4 v10, s[16:19], s85 offen lds
    ds_read_b64_tr_b16 a[40:41], v14 offset:0
    ds_read_b64_tr_b16 a[42:43], v14 offset:512
    v_mfma_f32_32x32x16_bf16 a[96:111], a[4:7], a[12:15], a[96:111]
    buffer_load_dwordx4 v11, s[16:19], s85 offen offset:1024 lds
    ds_read_b64_tr_b16 a[44:45], v34 offset:0
    ds_read_b64_tr_b16 a[46:47], v34 offset:512
    v_mfma_f32_32x32x16_bf16 v[16:31], a[0:3], a[8:11], v[16:31]
    s_waitcnt vmcnt(22)
    s_cmp_lg_u32 s3, 0
    s_cbranch_scc1 ECXF
ECHKF:
    s_mov_b64 s[84:85], 0
    s_cmp_le_u32 s97, 0
    s_cbranch_scc1 EC2F
    v_cmp_eq_u32 vcc, -1, v200
    s_or_b64 s[84:85], s[84:85], vcc
    v_cmp_eq_u32 vcc, -1, v201
    s_or_b64 s[84:85], s[84:85], vcc
    s_cmp_le_u32 s97, 1
    s_cbranch_scc1 EC2F
    v_cmp_eq_u32 vcc, -1, v202
    s_or_b64 s[84:85], s[84:85], vcc
    v_cmp_eq_u32 vcc, -1, v203
    s_or_b64 s[84:85], s[84:85], vcc
    s_cmp_le_u32 s97, 2
    s_cbranch_scc1 EC2F
    v_cmp_eq_u32 vcc, -1, v204
    s_or_b64 s[84:85], s[84:85], vcc
    v_cmp_eq_u32 vcc, -1, v205
    s_or_b64 s[84:85], s[84:85], vcc
    s_cmp_le_u32 s97, 3
    s_cbranch_scc1 EC2F
    v_cmp_eq_u32 vcc, -1, v206
    s_or_b64 s[84:85], s[84:85], vcc
    v_cmp_eq_u32 vcc, -1, v207
    s_or_b64 s[84:85], s[84:85], vcc
    s_cmp_le_u32 s97, 4
    s_cbranch_scc1 EC2F
    v_cmp_eq_u32 vcc, -1, v208
    s_or_b64 s[84:85], s[84:85], vcc
    v_cmp_eq_u32 vcc, -1, v209
    s_or_b64 s[84:85], s[84:85], vcc
    s_cmp_le_u32 s97, 5
    s_cbranch_scc1 EC2F
    v_cmp_eq_u32 vcc, -1, v210
    s_or_b64 s[84:85], s[84:85], vcc
    v_cmp_eq_u32 vcc, -1, v211
    s_or_b64 s[84:85], s[84:85], vcc
    s_cmp_le_u32 s97, 6
    s_cbranch_scc1 EC2F
    v_cmp_eq_u32 vcc, -1, v212
    s_or_b64 s[84:85], s[84:85], vcc
    v_cmp_eq_u32 vcc, -1, v213
    s_or_b64 s[84:85], s[84:85], vcc
    s_cmp_le_u32 s97, 7
    s_cbranch_scc1 EC2F
    v_cmp_eq_u32 vcc, -1, v214
    s_or_b64 s[84:85], s[84:85], vcc
    v_cmp_eq_u32 vcc, -1, v215
    s_or_b64 s[84:85], s[84:85], vcc
    s_cmp_le_u32 s97, 8
    s_cbranch_scc1 EC2F
    v_cmp_eq_u32 vcc, -1, v216
    s_or_b64 s[84:85], s[84:85], vcc
    v_cmp_eq_u32 vcc, -1, v217
    s_or_b64 s[84:85], s[84:85], vcc
    s_cmp_le_u32 s97, 9
    s_cbranch_scc1 EC2F
    v_cmp_eq_u32 vcc, -1, v218
    s_or_b64 s[84:85], s[84:85], vcc
    v_cmp_eq_u32 vcc, -1, v219
    s_or_b64 s[84:85], s[84:85], vcc
    s_cmp_le_u32 s97, 10
    s_cbranch_scc1 EC2F
    v_cmp_eq_u32 vcc, -1, v220
    s_or_b64 s[84:85], s[84:85], vcc
    v_cmp_eq_u32 vcc, -1, v221
    s_or_b64 s[84:85], s[84:85], vcc
    s_cmp_le_u32 s97, 11
    s_cbranch_scc1 EC2F
    v_cmp_eq_u32 vcc, -1, v222
    s_or_b64 s[84:85], s[84:85], vcc
    v_cmp_eq_u32 vcc, -1, v223
    s_or_b64 s[84:85], s[84:85], vcc
    s_cmp_le_u32 s97, 12
    s_cbranch_scc1 EC2F
    v_cmp_eq_u32 vcc, -1, v224
    s_or_b64 s[84:85], s[84:85], vcc
    v_cmp_eq_u32 vcc, -1, v225
    s_or_b64 s[84:85], s[84:85], vcc
    s_cmp_le_u32 s97, 13
    s_cbranch_scc1 EC2F
    v_cmp_eq_u32 vcc, -1, v226
    s_or_b64 s[84:85], s[84:85], vcc
    v_cmp_eq_u32 vcc, -1, v227
    s_or_b64 s[84:85], s[84:85], vcc
    s_cmp_le_u32 s97, 14
    s_cbranch_scc1 EC2F
    v_cmp_eq_u32 vcc, -1, v228
    s_or_b64 s[84:85], s[84:85], vcc
    v_cmp_eq_u32 vcc, -1, v229
    s_or_b64 s[84:85], s[84:85], vcc
EC2F:
    s_cmp_eq_u64 s[84:85], 0
    s_cbranch_scc1 EOKF
    s_cmp_eq_u32 s96, 0
    s_cbranch_scc1 EOKF
    s_sub_u32 s96, s96, 1
    s_sleep 1
    s_cmp_le_u32 s97, 0
    s_cbranch_scc1 ELF_3
    s_mov_b32 s84, 12582912
    buffer_load_dwordx2 v[200:201], v248, s[16:19], s84 offen sc1
    s_cmp_le_u32 s97, 1
    s_cbranch_scc1 ELF_3
    s_mov_b32 s84, 12587008
    buffer_load_dwordx2 v[202:203], v248, s[16:19], s84 offen sc1
    s_cmp_le_u32 s97, 2
    s_cbranch_scc1 ELF_3
    s_mov_b32 s84, 12591104
    buffer_load_dwordx2 v[204:205], v248, s[16:19], s84 offen sc1
    s_cmp_le_u32 s97, 3
    s_cbranch_scc1 ELF_3
    s_mov_b32 s84, 12595200
    buffer_load_dwordx2 v[206:207], v248, s[16:19], s84 offen sc1
    s_cmp_le_u32 s97, 4
    s_cbranch_scc1 ELF_3
    s_mov_b32 s84, 12599296
    buffer_load_dwordx2 v[208:209], v248, s[16:19], s84 offen sc1
    s_cmp_le_u32 s97, 5
    s_cbranch_scc1 ELF_3
    s_mov_b32 s84, 12603392
    buffer_load_dwordx2 v[210:211], v248, s[16:19], s84 offen sc1
    s_cmp_le_u32 s97, 6
    s_cbranch_scc1 ELF_3
    s_mov_b32 s84, 12607488
    buffer_load_dwordx2 v[212:213], v248, s[16:19], s84 offen sc1
    s_cmp_le_u32 s97, 7
    s_cbranch_scc1 ELF_3
    s_mov_b32 s84, 12611584
    buffer_load_dwordx2 v[214:215], v248, s[16:19], s84 offen sc1
    s_cmp_le_u32 s97, 8
    s_cbranch_scc1 ELF_3
    s_mov_b32 s84, 12615680
    buffer_load_dwordx2 v[216:217], v248, s[16:19], s84 offen sc1
    s_cmp_le_u32 s97, 9
    s_cbranch_scc1 ELF_3
    s_mov_b32 s84, 12619776
    buffer_load_dwordx2 v[218:219], v248, s[16:19], s84 offen sc1
    s_cmp_le_u32 s97, 10
    s_cbranch_scc1 ELF_3
    s_mov_b32 s84, 12623872
    buffer_load_dwordx2 v[220:221], v248, s[16:19], s84 offen sc1
    s_cmp_le_u32 s97, 11
    s_cbranch_scc1 ELF_3
    s_mov_b32 s84, 12627968
    buffer_load_dwordx2 v[222:223], v248, s[16:19], s84 offen sc1
    s_cmp_le_u32 s97, 12
    s_cbranch_scc1 ELF_3
    s_mov_b32 s84, 12632064
    buffer_load_dwordx2 v[224:225], v248, s[16:19], s84 offen sc1
    s_cmp_le_u32 s97, 13
    s_cbranch_scc1 ELF_3
    s_mov_b32 s84, 12636160
    buffer_load_dwordx2 v[226:227], v248, s[16:19], s84 offen sc1
    s_cmp_le_u32 s97, 14
    s_cbranch_scc1 ELF_3
    s_mov_b32 s84, 12640256
    buffer_load_dwordx2 v[228:229], v248, s[16:19], s84 offen sc1
    ELF_3:
    s_waitcnt vmcnt(0)
    s_branch ECHKF
EOKF:
    v_mov_b32 v240, 0
    v_mov_b32 v241, 0
    s_cmp_le_u32 s97, 0
    s_cbranch_scc1 CLF
    v_pk_fma_f32 v[200:201], v[238:239], v[240:241], v[200:201] op_sel_hi:[0,1,1]
    v_pk_fma_f32 v[240:241], v[238:239], v[240:241], v[200:201] op_sel:[1,1,0] op_sel_hi:[1,0,1] neg_lo:[1,0,0]
    s_cmp_le_u32 s97, 1
    s_cbranch_scc1 CLF
    v_pk_fma_f32 v[202:203], v[238:239], v[240:241], v[202:203] op_sel_hi:[0,1,1]
    v_pk_fma_f32 v[240:241], v[238:239], v[240:241], v[202:203] op_sel:[1,1,0] op_sel_hi:[1,0,1] neg_lo:[1,0,0]
    s_cmp_le_u32 s97, 2
    s_cbranch_scc1 CLF
    v_pk_fma_f32 v[204:205], v[238:239], v[240:241], v[204:205] op_sel_hi:[0,1,1]
    v_pk_fma_f32 v[240:241], v[238:239], v[240:241], v[204:205] op_sel:[1,1,0] op_sel_hi:[1,0,1] neg_lo:[1,0,0]
    s_cmp_le_u32 s97, 3
    s_cbranch_scc1 CLF
    v_pk_fma_f32 v[206:207], v[238:239], v[240:241], v[206:207] op_sel_hi:[0,1,1]
    v_pk_fma_f32 v[240:241], v[238:239], v[240:241], v[206:207] op_sel:[1,1,0] op_sel_hi:[1,0,1] neg_lo:[1,0,0]
    s_cmp_le_u32 s97, 4
    s_cbranch_scc1 CLF
    v_pk_fma_f32 v[208:209], v[238:239], v[240:241], v[208:209] op_sel_hi:[0,1,1]
    v_pk_fma_f32 v[240:241], v[238:239], v[240:241], v[208:209] op_sel:[1,1,0] op_sel_hi:[1,0,1] neg_lo:[1,0,0]
    s_cmp_le_u32 s97, 5
    s_cbranch_scc1 CLF
    v_pk_fma_f32 v[210:211], v[238:239], v[240:241], v[210:211] op_sel_hi:[0,1,1]
    v_pk_fma_f32 v[240:241], v[238:239], v[240:241], v[210:211] op_sel:[1,1,0] op_sel_hi:[1,0,1] neg_lo:[1,0,0]
    s_cmp_le_u32 s97, 6
    s_cbranch_scc1 CLF
    v_pk_fma_f32 v[212:213], v[238:239], v[240:241], v[212:213] op_sel_hi:[0,1,1]
    v_pk_fma_f32 v[240:241], v[238:239], v[240:241], v[212:213] op_sel:[1,1,0] op_sel_hi:[1,0,1] neg_lo:[1,0,0]
    s_cmp_le_u32 s97, 7
    s_cbranch_scc1 CLF
    v_pk_fma_f32 v[214:215], v[238:239], v[240:241], v[214:215] op_sel_hi:[0,1,1]
    v_pk_fma_f32 v[240:241], v[238:239], v[240:241], v[214:215] op_sel:[1,1,0] op_sel_hi:[1,0,1] neg_lo:[1,0,0]
    s_cmp_le_u32 s97, 8
    s_cbranch_scc1 CLF
    v_pk_fma_f32 v[216:217], v[238:239], v[240:241], v[216:217] op_sel_hi:[0,1,1]
    v_pk_fma_f32 v[240:241], v[238:239], v[240:241], v[216:217] op_sel:[1,1,0] op_sel_hi:[1,0,1] neg_lo:[1,0,0]
    s_cmp_le_u32 s97, 9
    s_cbranch_scc1 CLF
    v_pk_fma_f32 v[218:219], v[238:239], v[240:241], v[218:219] op_sel_hi:[0,1,1]
    v_pk_fma_f32 v[240:241], v[238:239], v[240:241], v[218:219] op_sel:[1,1,0] op_sel_hi:[1,0,1] neg_lo:[1,0,0]
    s_cmp_le_u32 s97, 10
    s_cbranch_scc1 CLF
    v_pk_fma_f32 v[220:221], v[238:239], v[240:241], v[220:221] op_sel_hi:[0,1,1]
    v_pk_fma_f32 v[240:241], v[238:239], v[240:241], v[220:221] op_sel:[1,1,0] op_sel_hi:[1,0,1] neg_lo:[1,0,0]
    s_cmp_le_u32 s97, 11
    s_cbranch_scc1 CLF
    v_pk_fma_f32 v[222:223], v[238:239], v[240:241], v[222:223] op_sel_hi:[0,1,1]
    v_pk_fma_f32 v[240:241], v[238:239], v[240:241], v[222:223] op_sel:[1,1,0] op_sel_hi:[1,0,1] neg_lo:[1,0,0]
    s_cmp_le_u32 s97, 12
    s_cbranch_scc1 CLF
    v_pk_fma_f32 v[224:225], v[238:239], v[240:241], v[224:225] op_sel_hi:[0,1,1]
    v_pk_fma_f32 v[240:241], v[238:239], v[240:241], v[224:225] op_sel:[1,1,0] op_sel_hi:[1,0,1] neg_lo:[1,0,0]
    s_cmp_le_u32 s97, 13
    s_cbranch_scc1 CLF
    v_pk_fma_f32 v[226:227], v[238:239], v[240:241], v[226:227] op_sel_hi:[0,1,1]
    v_pk_fma_f32 v[240:241], v[238:239], v[240:241], v[226:227] op_sel:[1,1,0] op_sel_hi:[1,0,1] neg_lo:[1,0,0]
    s_cmp_le_u32 s97, 14
    s_cbranch_scc1 CLF
    v_pk_fma_f32 v[228:229], v[238:239], v[240:241], v[228:229] op_sel_hi:[0,1,1]
    v_pk_fma_f32 v[240:241], v[238:239], v[240:241], v[228:229] op_sel:[1,1,0] op_sel_hi:[1,0,1] neg_lo:[1,0,0]
CLF:
    ds_write_b64 v247, v[240:241]
ECXF:
    ds_read_b64_tr_b16 a[0:1], v12 offset:16384
    ds_read_b64_tr_b16 a[2:3], v12 offset:16896
    s_waitcnt lgkmcnt(2)
    v_mfma_f32_32x32x16_bf16 a[64:79], a[32:35], a[44:47], a[64:79]
    s_mov_b32 s84, 2289664
    s_add_u32 m0, s83, 0
    s_nop 0
    buffer_load_dwordx4 v8, s[4:7], s84 offen lds
    ds_read_b64_tr_b16 a[4:5], v32 offset:16384
    ds_read_b64_tr_b16 a[6:7], v32 offset:16896
    v_mfma_f32_32x32x16_bf16 a[80:95], a[36:39], a[40:43], a[80:95]
    buffer_load_dwordx4 v9, s[4:7], s84 offen offset:1024 lds
    s_mov_b32 s85, 851968
    s_add_u32 m0, s83, 8192
    s_nop 0
    buffer_load_dwordx4 v10, s[16:19], s85 offen lds
    ds_read_b64_tr_b16 a[8:9], v14 offset:16384
    ds_read_b64_tr_b16 a[10:11], v14 offset:16896
    v_mfma_f32_32x32x16_bf16 a[96:111], a[36:39], a[44:47], a[96:111]
    buffer_load_dwordx4 v11, s[16:19], s85 offen offset:1024 lds
    ds_read_b64_tr_b16 a[12:13], v34 offset:16384
    ds_read_b64_tr_b16 a[14:15], v34 offset:16896
    v_mfma_f32_32x32x16_bf16 v[16:31], a[32:35], a[40:43], v[16:31]
    s_waitcnt lgkmcnt(0)
    s_waitcnt vmcnt(24)
    s_barrier
    ds_read_b64 v[240:241], v247
    ds_read_b64_tr_b16 a[32:33], v12 offset:32768
    ds_read_b64_tr_b16 a[34:35], v12 offset:33280
    s_waitcnt lgkmcnt(2)
    v_mfma_f32_32x32x16_bf16 a[64:79], a[0:3], a[12:15], a[64:79]
    s_mov_b32 s84, 2465792
    s_add_u32 m0, s83, 16384
    s_nop 0
    buffer_load_dwordx4 v8, s[4:7], s84 offen lds
    ds_read_b64_tr_b16 a[36:37], v32 offset:32768
    ds_read_b64_tr_b16 a[38:39], v32 offset:33280
    v_mfma_f32_32x32x16_bf16 a[80:95], a[4:7], a[8:11], a[80:95]
    buffer_load_dwordx4 v9, s[4:7], s84 offen offset:1024 lds
    s_mov_b32 s85, 917504
    s_add_u32 m0, s83, 24576
    s_nop 0
    buffer_load_dwordx4 v10, s[16:19], s85 offen lds
    ds_read_b64_tr_b16 a[40:41], v14 offset:32768
    ds_read_b64_tr_b16 a[42:43], v14 offset:33280
    v_mfma_f32_32x32x16_bf16 a[96:111], a[4:7], a[12:15], a[96:111]
    buffer_load_dwordx4 v11, s[16:19], s85 offen offset:1024 lds
    ds_read_b64_tr_b16 a[44:45], v34 offset:32768
    ds_read_b64_tr_b16 a[46:47], v34 offset:33280
    v_mfma_f32_32x32x16_bf16 v[16:31], a[0:3], a[8:11], v[16:31]
    v_fma_f32 v118, v194, v240, v110
    v_fma_f32 v119, v194, v241, v111
    v_fma_f32 v118, -v195, v241, v118
    v_fma_f32 v119, v195, v240, v119
    v_fma_f32 v120, v194, v118, v112
    v_fma_f32 v121, v194, v119, v113
    v_fma_f32 v120, -v195, v119, v120
    v_fma_f32 v121, v195, v118, v121
    v_fma_f32 v122, v194, v120, v114
    v_fma_f32 v123, v194, v121, v115
    v_fma_f32 v122, -v195, v121, v122
    v_fma_f32 v123, v195, v120, v123
    v_mov_b32 v88, v240
    v_mov_b32 v97, v241
    s_cmp_eq_u32 s3, 1
    s_cselect_b64 vcc, -1, 0
    v_cndmask_b32 v88, v88, v118, vcc
    v_cndmask_b32 v97, v97, v119, vcc
    s_cmp_eq_u32 s3, 2
    s_cselect_b64 vcc, -1, 0
    v_cndmask_b32 v88, v88, v120, vcc
    v_cndmask_b32 v97, v97, v121, vcc
    s_cmp_eq_u32 s3, 3
    s_cselect_b64 vcc, -1, 0
    v_cndmask_b32 v88, v88, v122, vcc
    v_cndmask_b32 v97, v97, v123, vcc
    v_fma_f32 v89, v190, v88, v72
    v_fma_f32 v98, v190, v97, v76
    v_fma_f32 v89, -v191, v97, v89
    v_fma_f32 v98, v191, v88, v98
    v_fma_f32 v90, v190, v89, v80
    v_fma_f32 v99, v190, v98, v84
    v_fma_f32 v90, -v191, v98, v90
    v_fma_f32 v99, v191, v89, v99
    v_fma_f32 v91, v190, v90, v73
    v_fma_f32 v100, v190, v99, v77
    v_fma_f32 v91, -v191, v99, v91
    v_fma_f32 v100, v191, v90, v100
    s_waitcnt vmcnt(24)
    ds_read_b64_tr_b16 a[0:1], v12 offset:49152
    ds_read_b64_tr_b16 a[2:3], v12 offset:49664
    s_waitcnt lgkmcnt(2)
    v_mfma_f32_32x32x16_bf16 a[64:79], a[32:35], a[44:47], a[64:79]
    s_mov_b32 s84, 2641920
    s_add_u32 m0, s83, 32768
    s_nop 0
    buffer_load_dwordx4 v8, s[4:7], s84 offen lds
    ds_read_b64_tr_b16 a[4:5], v32 offset:49152
    ds_read_b64_tr_b16 a[6:7], v32 offset:49664
    v_mfma_f32_32x32x16_bf16 a[80:95], a[36:39], a[40:43], a[80:95]
    buffer_load_dwordx4 v9, s[4:7], s84 offen offset:1024 lds
    s_mov_b32 s85, 983040
    s_add_u32 m0, s83, 40960
    s_nop 0
    buffer_load_dwordx4 v10, s[16:19], s85 offen lds
    ds_read_b64_tr_b16 a[8:9], v14 offset:49152
    ds_read_b64_tr_b16 a[10:11], v14 offset:49664
    v_mfma_f32_32x32x16_bf16 a[96:111], a[36:39], a[44:47], a[96:111]
    buffer_load_dwordx4 v11, s[16:19], s85 offen offset:1024 lds
    ds_read_b64_tr_b16 a[12:13], v34 offset:49152
    ds_read_b64_tr_b16 a[14:15], v34 offset:49664
    v_mfma_f32_32x32x16_bf16 v[16:31], a[32:35], a[40:43], v[16:31]
    v_fma_f32 v92, v190, v91, v81
    v_fma_f32 v101, v190, v100, v85
    v_fma_f32 v92, -v191, v100, v92
    v_fma_f32 v101, v191, v91, v101
    v_fma_f32 v93, v190, v92, v74
    v_fma_f32 v102, v190, v101, v78
    v_fma_f32 v93, -v191, v101, v93
    v_fma_f32 v102, v191, v92, v102
    v_fma_f32 v94, v190, v93, v82
    v_fma_f32 v103, v190, v102, v86
    v_fma_f32 v94, -v191, v102, v94
    v_fma_f32 v103, v191, v93, v103
    v_fma_f32 v95, v190, v94, v75
    v_fma_f32 v104, v190, v103, v79
    v_fma_f32 v95, -v191, v103, v95
    v_fma_f32 v104, v191, v94, v104
    v_cmp_lt_u32 vcc, 31, v1
    s_nop 0
    v_cndmask_b32 v114, v88, v89, vcc
    v_cndmask_b32 v118, v97, v98, vcc
    v_cndmask_b32 v115, v90, v91, vcc
    v_cndmask_b32 v119, v99, v100, vcc
    v_cndmask_b32 v116, v92, v93, vcc
    v_cndmask_b32 v120, v101, v102, vcc
    v_cndmask_b32 v117, v94, v95, vcc
    v_cndmask_b32 v121, v103, v104, vcc
    v_mul_f32 v106, v234, v114
    v_mul_f32 v110, v234, v118
    v_fma_f32 v106, -v235, v118, v106
    v_fma_f32 v110, v235, v114, v110
    v_mul_f32 v107, v234, v115
    v_mul_f32 v111, v234, v119
    v_fma_f32 v107, -v235, v119, v107
    v_fma_f32 v111, v235, v115, v111
    v_mul_f32 v108, v234, v116
    v_mul_f32 v112, v234, v120
    v_fma_f32 v108, -v235, v120, v108
    v_fma_f32 v112, v235, v116, v112
    v_mul_f32 v109, v234, v117
    v_mul_f32 v113, v234, v121
    v_fma_f32 v109, -v235, v121, v109
    v_fma_f32 v113, v235, v117, v113
    s_waitcnt vmcnt(24)
    ds_read_b64_tr_b16 a[32:33], v13 offset:0
    ds_read_b64_tr_b16 a[34:35], v13 offset:512
    s_waitcnt lgkmcnt(2)
    v_mfma_f32_32x32x16_bf16 a[64:79], a[0:3], a[12:15], a[64:79]
    s_mov_b32 s84, 2818048
    s_add_u32 m0, s83, 49152
    s_nop 0
    buffer_load_dwordx4 v8, s[4:7], s84 offen lds
    ds_read_b64_tr_b16 a[36:37], v33 offset:0
    ds_read_b64_tr_b16 a[38:39], v33 offset:512
    v_mfma_f32_32x32x16_bf16 a[80:95], a[4:7], a[8:11], a[80:95]
    buffer_load_dwordx4 v9, s[4:7], s84 offen offset:1024 lds
    s_mov_b32 s85, 1048576
    s_add_u32 m0, s83, 57344
    s_nop 0
    buffer_load_dwordx4 v10, s[16:19], s85 offen lds
    ds_read_b64_tr_b16 a[40:41], v15 offset:0
    ds_read_b64_tr_b16 a[42:43], v15 offset:512
    v_mfma_f32_32x32x16_bf16 a[96:111], a[4:7], a[12:15], a[96:111]
    buffer_load_dwordx4 v11, s[16:19], s85 offen offset:1024 lds
    ds_read_b64_tr_b16 a[44:45], v35 offset:0
    ds_read_b64_tr_b16 a[46:47], v35 offset:512
    v_mfma_f32_32x32x16_bf16 v[16:31], a[0:3], a[8:11], v[16:31]
    v_fma_f32 v40, v184, v106, v40
    v_fma_f32 v56, -v184, v110, v56
    v_fma_f32 v40, -v185, v110, v40
    v_fma_f32 v56, -v185, v106, v56
    v_cvt_pk_bf16_f32 v40, v40, v56
    ds_write_b16 v232, v40 offset:0
    ds_write_b16_d16_hi v249, v40 offset:0
    v_fma_f32 v41, v186, v106, v41
    v_fma_f32 v57, -v186, v110, v57
    v_fma_f32 v41, -v187, v110, v41
    v_fma_f32 v57, -v187, v106, v57
    v_cvt_pk_bf16_f32 v41, v41, v57
    ds_write_b16 v232, v41 offset:128
    ds_write_b16_d16_hi v249, v41 offset:128
    v_fma_f32 v42, v188, v106, v42
    v_fma_f32 v58, -v188, v110, v58
    v_fma_f32 v42, -v189, v110, v42
    v_fma_f32 v58, -v189, v106, v58
    v_cvt_pk_bf16_f32 v42, v42, v58
    ds_write_b16 v232, v42 offset:256
    ds_write_b16_d16_hi v249, v42 offset:256
    v_fma_f32 v43, v190, v106, v43
    v_fma_f32 v59, -v190, v110, v59
    v_fma_f32 v43, -v191, v110, v43
    v_fma_f32 v59, -v191, v106, v59
    v_cvt_pk_bf16_f32 v43, v43, v59
    ds_write_b16 v232, v43 offset:384
    ds_write_b16_d16_hi v249, v43 offset:384
    v_fma_f32 v44, v184, v107, v44
    v_fma_f32 v60, -v184, v111, v60
    v_fma_f32 v44, -v185, v111, v44
    v_fma_f32 v60, -v185, v107, v60
    v_cvt_pk_bf16_f32 v44, v44, v60
    ds_write_b16 v232, v44 offset:1024
    ds_write_b16_d16_hi v249, v44 offset:1024
    v_fma_f32 v45, v186, v107, v45
    v_fma_f32 v61, -v186, v111, v61
    v_fma_f32 v45, -v187, v111, v45
    v_fma_f32 v61, -v187, v107, v61
    v_cvt_pk_bf16_f32 v45, v45, v61
    ds_write_b16 v232, v45 offset:1152
    ds_write_b16_d16_hi v249, v45 offset:1152
    v_fma_f32 v46, v188, v107, v46
    v_fma_f32 v62, -v188, v111, v62
    v_fma_f32 v46, -v189, v111, v46
    v_fma_f32 v62, -v189, v107, v62
    v_cvt_pk_bf16_f32 v46, v46, v62
    ds_write_b16 v232, v46 offset:1280
    ds_write_b16_d16_hi v249, v46 offset:1280
    v_fma_f32 v47, v190, v107, v47
    v_fma_f32 v63, -v190, v111, v63
    v_fma_f32 v47, -v191, v111, v47
    v_fma_f32 v63, -v191, v107, v63
    v_cvt_pk_bf16_f32 v47, v47, v63
    ds_write_b16 v232, v47 offset:1408
    ds_write_b16_d16_hi v249, v47 offset:1408
    s_waitcnt vmcnt(24)
    ds_read_b64_tr_b16 a[0:1], v13 offset:16384
    ds_read_b64_tr_b16 a[2:3], v13 offset:16896
    s_waitcnt lgkmcnt(2)
    v_mfma_f32_32x32x16_bf16 a[64:79], a[32:35], a[44:47], a[64:79]
    s_mov_b32 s84, 2994176
    s_add_u32 m0, s83, 65536
    s_nop 0
    buffer_load_dwordx4 v8, s[4:7], s84 offen lds
    ds_read_b64_tr_b16 a[4:5], v33 offset:16384
    ds_read_b64_tr_b16 a[6:7], v33 offset:16896
    v_mfma_f32_32x32x16_bf16 a[80:95], a[36:39], a[40:43], a[80:95]
    buffer_load_dwordx4 v9, s[4:7], s84 offen offset:1024 lds
    s_mov_b32 s85, 1114112
    s_add_u32 m0, s83, 73728
    s_nop 0
    buffer_load_dwordx4 v10, s[16:19], s85 offen lds
    ds_read_b64_tr_b16 a[8:9], v15 offset:16384
    ds_read_b64_tr_b16 a[10:11], v15 offset:16896
    v_mfma_f32_32x32x16_bf16 a[96:111], a[36:39], a[44:47], a[96:111]
    buffer_load_dwordx4 v11, s[16:19], s85 offen offset:1024 lds
    ds_read_b64_tr_b16 a[12:13], v35 offset:16384
    ds_read_b64_tr_b16 a[14:15], v35 offset:16896
    v_mfma_f32_32x32x16_bf16 v[16:31], a[32:35], a[40:43], v[16:31]
    v_fma_f32 v48, v184, v108, v48
    v_fma_f32 v64, -v184, v112, v64
    v_fma_f32 v48, -v185, v112, v48
    v_fma_f32 v64, -v185, v108, v64
    v_cvt_pk_bf16_f32 v48, v48, v64
    ds_write_b16 v232, v48 offset:2048
    ds_write_b16_d16_hi v249, v48 offset:2048
    v_fma_f32 v49, v186, v108, v49
    v_fma_f32 v65, -v186, v112, v65
    v_fma_f32 v49, -v187, v112, v49
    v_fma_f32 v65, -v187, v108, v65
    v_cvt_pk_bf16_f32 v49, v49, v65
    ds_write_b16 v232, v49 offset:2176
    ds_write_b16_d16_hi v249, v49 offset:2176
    v_fma_f32 v50, v188, v108, v50
    v_fma_f32 v66, -v188, v112, v66
    v_fma_f32 v50, -v189, v112, v50
    v_fma_f32 v66, -v189, v108, v66
    v_cvt_pk_bf16_f32 v50, v50, v66
    ds_write_b16 v232, v50 offset:2304
    ds_write_b16_d16_hi v249, v50 offset:2304
    v_fma_f32 v51, v190, v108, v51
    v_fma_f32 v67, -v190, v112, v67
    v_fma_f32 v51, -v191, v112, v51
    v_fma_f32 v67, -v191, v108, v67
    v_cvt_pk_bf16_f32 v51, v51, v67
    ds_write_b16 v232, v51 offset:2432
    ds_write_b16_d16_hi v249, v51 offset:2432
    v_fma_f32 v52, v184, v109, v52
    v_fma_f32 v68, -v184, v113, v68
    v_fma_f32 v52, -v185, v113, v52
    v_fma_f32 v68, -v185, v109, v68
    v_cvt_pk_bf16_f32 v52, v52, v68
    ds_write_b16 v232, v52 offset:3072
    ds_write_b16_d16_hi v249, v52 offset:3072
    v_fma_f32 v53, v186, v109, v53
    v_fma_f32 v69, -v186, v113, v69
    v_fma_f32 v53, -v187, v113, v53
    v_fma_f32 v69, -v187, v109, v69
    v_cvt_pk_bf16_f32 v53, v53, v69
    ds_write_b16 v232, v53 offset:3200
    ds_write_b16_d16_hi v249, v53 offset:3200
    v_fma_f32 v54, v188, v109, v54
    v_fma_f32 v70, -v188, v113, v70
    v_fma_f32 v54, -v189, v113, v54
    v_fma_f32 v70, -v189, v109, v70
    v_cvt_pk_bf16_f32 v54, v54, v70
    ds_write_b16 v232, v54 offset:3328
    ds_write_b16_d16_hi v249, v54 offset:3328
    v_fma_f32 v55, v190, v109, v55
    v_fma_f32 v71, -v190, v113, v71
    v_fma_f32 v55, -v191, v113, v55
    v_fma_f32 v71, -v191, v109, v71
    v_cvt_pk_bf16_f32 v55, v55, v71
    ds_write_b16 v232, v55 offset:3456
    ds_write_b16_d16_hi v249, v55 offset:3456
    s_waitcnt vmcnt(24)
    ds_read_b128 v[72:75], v233 offset:0
    ds_read_b128 v[76:79], v233 offset:1024
    ds_read_b128 v[80:83], v233 offset:2048
    ds_read_b128 v[84:87], v233 offset:3072
    ds_read_b64_tr_b16 a[32:33], v13 offset:32768
    ds_read_b64_tr_b16 a[34:35], v13 offset:33280
    s_waitcnt lgkmcnt(2)
    v_mfma_f32_32x32x16_bf16 a[64:79], a[0:3], a[12:15], a[64:79]
    s_mov_b32 s84, 3170304
    s_add_u32 m0, s83, 81920
    s_nop 0
    buffer_load_dwordx4 v8, s[4:7], s84 offen lds
    ds_read_b64_tr_b16 a[36:37], v33 offset:32768
    ds_read_b64_tr_b16 a[38:39], v33 offset:33280
    v_mfma_f32_32x32x16_bf16 a[80:95], a[4:7], a[8:11], a[80:95]
    buffer_load_dwordx4 v9, s[4:7], s84 offen offset:1024 lds
    s_mov_b32 s85, 1179648
    s_add_u32 m0, s83, 90112
    s_nop 0
    buffer_load_dwordx4 v10, s[16:19], s85 offen lds
    ds_read_b64_tr_b16 a[40:41], v15 offset:32768
    ds_read_b64_tr_b16 a[42:43], v15 offset:33280
    v_mfma_f32_32x32x16_bf16 a[96:111], a[4:7], a[12:15], a[96:111]
    buffer_load_dwordx4 v11, s[16:19], s85 offen offset:1024 lds
    ds_read_b64_tr_b16 a[44:45], v35 offset:32768
    ds_read_b64_tr_b16 a[46:47], v35 offset:33280
    v_mfma_f32_32x32x16_bf16 v[16:31], a[0:3], a[8:11], v[16:31]
    s_add_u32 s84, s98, 0
    buffer_store_dwordx4 v[72:75], v242, s[16:19], s84 offen sc1
    s_add_u32 s84, s98, 16384
    buffer_store_dwordx4 v[76:79], v242, s[16:19], s84 offen sc1
    s_add_u32 s84, s98, 32768
    buffer_store_dwordx4 v[80:83], v242, s[16:19], s84 offen sc1
    s_add_u32 s84, s98, 49152
    buffer_store_dwordx4 v[84:87], v242, s[16:19], s84 offen sc1
    s_waitcnt vmcnt(28)
    ds_read_b64_tr_b16 a[0:1], v13 offset:49152
    ds_read_b64_tr_b16 a[2:3], v13 offset:49664
    s_waitcnt lgkmcnt(2)
    v_mfma_f32_32x32x16_bf16 a[64:79], a[32:35], a[44:47], a[64:79]
    s_mov_b32 s84, 3346432
    s_add_u32 m0, s83, 98304
    s_nop 0
    buffer_load_dwordx4 v8, s[4:7], s84 offen lds
    ds_read_b64_tr_b16 a[4:5], v33 offset:49152
    ds_read_b64_tr_b16 a[6:7], v33 offset:49664
    v_mfma_f32_32x32x16_bf16 a[80:95], a[36:39], a[40:43], a[80:95]
    buffer_load_dwordx4 v9, s[4:7], s84 offen offset:1024 lds
    s_mov_b32 s85, 1245184
    s_add_u32 m0, s83, 106496
    s_nop 0
    buffer_load_dwordx4 v10, s[16:19], s85 offen lds
    ds_read_b64_tr_b16 a[8:9], v15 offset:49152
    ds_read_b64_tr_b16 a[10:11], v15 offset:49664
    v_mfma_f32_32x32x16_bf16 a[96:111], a[36:39], a[44:47], a[96:111]
    buffer_load_dwordx4 v11, s[16:19], s85 offen offset:1024 lds
    ds_read_b64_tr_b16 a[12:13], v35 offset:49152
    ds_read_b64_tr_b16 a[14:15], v35 offset:49664
    v_mfma_f32_32x32x16_bf16 v[16:31], a[32:35], a[40:43], v[16:31]
    buffer_load_dwordx2 v[128:129], v2, s[8:11], 0 offen offset:0
    buffer_load_dwordx2 v[130:131], v2, s[8:11], 0 offen offset:16
    buffer_load_dwordx2 v[132:133], v2, s[8:11], 0 offen offset:32
    buffer_load_dwordx2 v[134:135], v2, s[8:11], 0 offen offset:48
    s_waitcnt vmcnt(32)
    ds_read_b64_tr_b16 a[32:33], v12 offset:0
    ds_read_b64_tr_b16 a[34:35], v12 offset:512
    s_waitcnt lgkmcnt(2)
    v_mfma_f32_32x32x16_bf16 a[64:79], a[0:3], a[12:15], a[64:79]
    s_mov_b32 s84, 3522560
    s_add_u32 m0, s83, 114688
    s_nop 0
    buffer_load_dwordx4 v8, s[4:7], s84 offen lds
    ds_read_b64_tr_b16 a[36:37], v32 offset:0
    ds_read_b64_tr_b16 a[38:39], v32 offset:512
    v_mfma_f32_32x32x16_bf16 a[80:95], a[4:7], a[8:11], a[80:95]
    buffer_load_dwordx4 v9, s[4:7], s84 offen offset:1024 lds
    s_mov_b32 s85, 1310720
    s_add_u32 m0, s83, 122880
    s_nop 0
    buffer_load_dwordx4 v10, s[16:19], s85 offen lds
    ds_read_b64_tr_b16 a[40:41], v14 offset:0
    ds_read_b64_tr_b16 a[42:43], v14 offset:512
    v_mfma_f32_32x32x16_bf16 a[96:111], a[4:7], a[12:15], a[96:111]
    buffer_load_dwordx4 v11, s[16:19], s85 offen offset:1024 lds
    ds_read_b64_tr_b16 a[44:45], v34 offset:0
    ds_read_b64_tr_b16 a[46:47], v34 offset:512
    v_mfma_f32_32x32x16_bf16 v[16:31], a[0:3], a[8:11], v[16:31]
    s_and_b32 s72, s2, 7
    s_lshr_b32 s73, s2, 3
    s_lshr_b32 s74, s73, 3
    s_lshl_b32 s72, s72, 2
    s_add_u32 s72, s72, s74
    s_and_b32 s73, s73, 7
    s_lshr_b32 s86, s72, 1
    s_lshl_b32 s86, s86, 7
    s_add_u32 s97, s86, 13647872
    v_and_b32 v4, 15, v1
    v_lshlrev_b32 v226, 2, v4
    v_min_u32 v4, 21, v1
    v_lshlrev_b32 v228, 2, v4
    s_and_b32 s98, s72, 7
    s_lshl_b32 s98, s98, 3
    s_add_u32 s98, s98, s73
    s_lshl_b32 s98, s98, 7
    s_add_u32 s98, s98, 13664256
    s_lshl_b32 s74, s72, 6
    s_lshl_b32 s75, s73, 6
    s_lshr_b32 s76, s3, 1
    s_and_b32 s77, s3, 1
    v_and_b32 v3, 31, v1
    s_lshl_b32 s78, s77, 5
    s_add_u32 s78, s78, s74
    v_add_u32 v3, s78, v3
    v_lshrrev_b32 v176, 3, v3
    v_lshlrev_b32 v176, 7, v176
    v_and_b32 v4, 7, v3
    v_lshl_add_u32 v176, v4, 2, v176
    v_lshlrev_b32 v177, 1, v3
    s_lshl_b32 s79, s76, 5
    s_add_u32 s79, s79, s75
    v_lshrrev_b32 v4, 5, v1
    v_lshlrev_b32 v4, 2, v4
    v_add_u32 v4, s79, v4
    v_lshlrev_b32 v178, 1, v4
    v_lshl_add_u32 v179, v3, 10, v178
    v_lshlrev_b32 v198, 1, v179
    v_lshrrev_b32 v4, 2, v1
    v_add_u32 v4, s78, v4
    v_lshlrev_b32 v4, 10, v4
    v_and_b32 v5, 3, v1
    v_lshl_add_u32 v4, v5, 4, v4
    s_lshl_b32 s80, s79, 1
    v_add_u32 v179, s80, v4
    v_lshrrev_b32 v4, 3, v1
    v_lshrrev_b32 v5, 4, v1
    v_and_b32 v6, 7, v1
    v_add_u32 v7, s78, v4
    v_lshlrev_b32 v7, 11, v7
    v_lshl_add_u32 v7, v6, 4, v7
    s_lshl_b32 s80, s79, 2
    v_add_u32 v198, s80, v7
    s_lshl_b32 s80, s3, 4
    s_add_u32 s81, s80, s75
    s_add_u32 s82, s80, s74
    s_waitcnt vmcnt(32)
    ds_read_b64_tr_b16 a[0:1], v12 offset:16384
    ds_read_b64_tr_b16 a[2:3], v12 offset:16896
    s_waitcnt lgkmcnt(2)
    v_mfma_f32_32x32x16_bf16 a[64:79], a[32:35], a[44:47], a[64:79]
    s_mov_b32 s84, 3698688
    s_add_u32 m0, s83, 0
    s_nop 0
    buffer_load_dwordx4 v8, s[4:7], s84 offen lds
    ds_read_b64_tr_b16 a[4:5], v32 offset:16384
    ds_read_b64_tr_b16 a[6:7], v32 offset:16896
    v_mfma_f32_32x32x16_bf16 a[80:95], a[36:39], a[40:43], a[80:95]
    buffer_load_dwordx4 v9, s[4:7], s84 offen offset:1024 lds
    s_mov_b32 s85, 1376256
    s_add_u32 m0, s83, 8192
    s_nop 0
    buffer_load_dwordx4 v10, s[16:19], s85 offen lds
    ds_read_b64_tr_b16 a[8:9], v14 offset:16384
    ds_read_b64_tr_b16 a[10:11], v14 offset:16896
    v_mfma_f32_32x32x16_bf16 a[96:111], a[36:39], a[44:47], a[96:111]
    buffer_load_dwordx4 v11, s[16:19], s85 offen offset:1024 lds
    ds_read_b64_tr_b16 a[12:13], v34 offset:16384
    ds_read_b64_tr_b16 a[14:15], v34 offset:16896
    v_mfma_f32_32x32x16_bf16 v[16:31], a[32:35], a[40:43], v[16:31]
    s_mov_b32 s86, 1024
    s_mov_b32 s87, 0
    v_add_u32 v7, 0, v5
    v_and_b32 v7, 7, v7
    v_xor_b32 v7, v7, v6
    v_lshlrev_b32 v7, 4, v7
    v_add_u32 v200, s81, v4
    v_mul_lo_u32 v200, v200, s86
    v_add_u32 v200, v200, v7
    v_add_u32 v200, s87, v200
    v_add_u32 v7, 4, v5
    v_and_b32 v7, 7, v7
    v_xor_b32 v7, v7, v6
    v_lshlrev_b32 v7, 4, v7
    v_add_u32 v201, s81, v4
    v_add_u32 v201, 8, v201
    v_mul_lo_u32 v201, v201, s86
    v_add_u32 v201, v201, v7
    v_add_u32 v201, s87, v201
    v_subrev_u32 v201, 1024, v201
    s_mov_b32 s86, 2048
    s_mov_b32 s87, 16777216
    v_add_u32 v7, 0, v5
    v_and_b32 v7, 7, v7
    v_xor_b32 v7, v7, v6
    v_and_b32 v202, 4, v7
    v_add_u32 v7, v7, v202
    v_lshlrev_b32 v7, 4, v7
    v_add_u32 v202, s82, v4
    v_mul_lo_u32 v202, v202, s86
    v_add_u32 v202, v202, v7
    v_add_u32 v202, s87, v202
    v_add_u32 v7, 4, v5
    v_and_b32 v7, 7, v7
    v_xor_b32 v7, v7, v6
    v_and_b32 v203, 4, v7
    v_add_u32 v7, v7, v203
    v_lshlrev_b32 v7, 4, v7
    v_add_u32 v203, s82, v4
    v_add_u32 v203, 8, v203
    v_mul_lo_u32 v203, v203, s86
    v_add_u32 v203, v203, v7
    v_add_u32 v203, s87, v203
    v_subrev_u32 v203, 1024, v203
    s_and_b32 s86, s73, 3
    s_lshl_b32 s86, s86, 4
    s_add_u32 s86, s86, s74
    s_lshl_b32 s86, s86, 11
    s_add_u32 s86, s86, s87
    v_lshlrev_b32 v230, 7, v0
    v_add_u32 v230, s86, v230
    s_waitcnt vmcnt(32)
    ds_read_b64_tr_b16 a[32:33], v12 offset:32768
    ds_read_b64_tr_b16 a[34:35], v12 offset:33280
    s_waitcnt lgkmcnt(2)
    v_mfma_f32_32x32x16_bf16 a[64:79], a[0:3], a[12:15], a[64:79]
    s_mov_b32 s84, 3874816
    s_add_u32 m0, s83, 16384
    s_nop 0
    buffer_load_dwordx4 v8, s[4:7], s84 offen lds
    ds_read_b64_tr_b16 a[36:37], v32 offset:32768
    ds_read_b64_tr_b16 a[38:39], v32 offset:33280
    v_mfma_f32_32x32x16_bf16 a[80:95], a[4:7], a[8:11], a[80:95]
    buffer_load_dwordx4 v9, s[4:7], s84 offen offset:1024 lds
    s_mov_b32 s85, 1441792
    s_add_u32 m0, s83, 24576
    s_nop 0
    buffer_load_dwordx4 v10, s[16:19], s85 offen lds
    ds_read_b64_tr_b16 a[40:41], v14 offset:32768
    ds_read_b64_tr_b16 a[42:43], v14 offset:33280
    v_mfma_f32_32x32x16_bf16 a[96:111], a[4:7], a[12:15], a[96:111]
    buffer_load_dwordx4 v11, s[16:19], s85 offen offset:1024 lds
    ds_read_b64_tr_b16 a[44:45], v34 offset:32768
    ds_read_b64_tr_b16 a[46:47], v34 offset:33280
    v_mfma_f32_32x32x16_bf16 v[16:31], a[0:3], a[8:11], v[16:31]
    s_mov_b32 s86, 2816
    s_mov_b32 s87, 20971520
    v_add_u32 v7, 0, v5
    v_and_b32 v7, 7, v7
    v_xor_b32 v7, v7, v6
    v_lshlrev_b32 v7, 4, v7
    v_add_u32 v204, s81, v4
    v_mul_lo_u32 v204, v204, s86
    v_add_u32 v204, v204, v7
    v_add_u32 v204, s87, v204
    v_add_u32 v7, 4, v5
    v_and_b32 v7, 7, v7
    v_xor_b32 v7, v7, v6
    v_lshlrev_b32 v7, 4, v7
    v_add_u32 v205, s81, v4
    v_add_u32 v205, 8, v205
    v_mul_lo_u32 v205, v205, s86
    v_add_u32 v205, v205, v7
    v_add_u32 v205, s87, v205
    v_subrev_u32 v205, 1024, v205
    s_mov_b32 s86, 4096
    s_lshl_b32 s87, s74, 1
    v_and_b32 v7, 1, v5
    v_lshlrev_b32 v7, 2, v7
    v_xor_b32 v7, v7, v6
    v_lshlrev_b32 v7, 4, v7
    v_add_u32 v206, s80, v4
    v_mul_lo_u32 v206, v206, s86
    v_add_u32 v206, v206, v7
    v_add_u32 v206, s87, v206
    v_and_b32 v7, 1, v5
    v_lshlrev_b32 v7, 2, v7
    v_xor_b32 v7, v7, v6
    v_lshlrev_b32 v7, 4, v7
    v_add_u32 v207, s80, v4
    v_add_u32 v207, 8, v207
    v_mul_lo_u32 v207, v207, s86
    v_add_u32 v207, v207, v7
    v_add_u32 v207, s87, v207
    v_subrev_u32 v207, 1024, v207
    s_waitcnt vmcnt(32)
    ds_read_b64_tr_b16 a[0:1], v12 offset:49152
    ds_read_b64_tr_b16 a[2:3], v12 offset:49664
    s_waitcnt lgkmcnt(2)
    v_mfma_f32_32x32x16_bf16 a[64:79], a[32:35], a[44:47], a[64:79]
    s_mov_b32 s84, 4050944
    s_add_u32 m0, s83, 32768
    s_nop 0
    buffer_load_dwordx4 v8, s[4:7], s84 offen lds
    ds_read_b64_tr_b16 a[4:5], v32 offset:49152
    ds_read_b64_tr_b16 a[6:7], v32 offset:49664
    v_mfma_f32_32x32x16_bf16 a[80:95], a[36:39], a[40:43], a[80:95]
    buffer_load_dwordx4 v9, s[4:7], s84 offen offset:1024 lds
    s_mov_b32 s85, 1507328
    s_add_u32 m0, s83, 40960
    s_nop 0
    buffer_load_dwordx4 v10, s[16:19], s85 offen lds
    ds_read_b64_tr_b16 a[8:9], v14 offset:49152
    ds_read_b64_tr_b16 a[10:11], v14 offset:49664
    v_mfma_f32_32x32x16_bf16 a[96:111], a[36:39], a[44:47], a[96:111]
    buffer_load_dwordx4 v11, s[16:19], s85 offen offset:1024 lds
    ds_read_b64_tr_b16 a[12:13], v34 offset:49152
    ds_read_b64_tr_b16 a[14:15], v34 offset:49664
    v_mfma_f32_32x32x16_bf16 v[16:31], a[32:35], a[40:43], v[16:31]
    s_lshl_b32 s86, s76, 12
    s_lshl_b32 s87, s77, 12
    s_lshl_b32 s88, s77, 2
    v_and_b32 v113, 31, v1
    v_lshrrev_b32 v114, 1, v113
    v_and_b32 v114, 7, v114
    v_lshrrev_b32 v180, 5, v1
    v_xor_b32 v114, v114, v180
    v_lshlrev_b32 v114, 4, v114
    v_lshl_add_u32 v114, v113, 7, v114
    v_add_u32 v114, s86, v114
    v_xor_b32 v180, 0, v114
    v_add_u32 v184, 65536, v180
    v_xor_b32 v181, 32, v114
    v_add_u32 v185, 65536, v181
    v_xor_b32 v182, 64, v114
    v_add_u32 v186, 65536, v182
    v_xor_b32 v183, 96, v114
    v_add_u32 v187, 65536, v183
    v_and_b32 v113, 31, v1
    v_lshrrev_b32 v114, 1, v113
    v_and_b32 v114, 7, v114
    v_lshrrev_b32 v188, 5, v1
    v_xor_b32 v114, v114, v188
    v_lshlrev_b32 v114, 4, v114
    v_lshl_add_u32 v114, v113, 7, v114
    v_add_u32 v114, s87, v114
    v_add_u32 v114, 8192, v114
    v_xor_b32 v188, 0, v114
    v_add_u32 v192, 65536, v188
    v_xor_b32 v189, 32, v114
    v_add_u32 v193, 65536, v189
    v_xor_b32 v190, 64, v114
    v_add_u32 v194, 65536, v190
    v_xor_b32 v191, 96, v114
    v_add_u32 v195, 65536, v191
    v_and_b32 v113, 15, v1
    v_lshrrev_b32 v114, 4, v1
    v_and_b32 v114, 1, v114
    v_lshlrev_b32 v114, 1, v114
    v_bfe_u32 v115, v113, 1, 1
    v_add_u32 v114, v114, v115
    v_add_u32 v114, s88, v114
    v_bfe_u32 v115, v113, 3, 1
    v_lshlrev_b32 v115, 2, v115
    v_xor_b32 v114, v114, v115
    v_lshlrev_b32 v114, 4, v114
    v_and_b32 v115, 1, v113
    v_lshl_add_u32 v114, v115, 3, v114
    v_lshrrev_b32 v115, 2, v113
    v_lshrrev_b32 v113, 5, v1
    v_lshl_add_u32 v115, v113, 3, v115
    v_lshl_add_u32 v196, v115, 7, v114
    v_add_u32 v196, 8192, v196
    v_add_u32 v197, 65536, v196
    s_waitcnt vmcnt(32)
    ds_read_b64_tr_b16 a[32:33], v13 offset:0
    ds_read_b64_tr_b16 a[34:35], v13 offset:512
    s_waitcnt lgkmcnt(2)
    v_mfma_f32_32x32x16_bf16 a[64:79], a[0:3], a[12:15], a[64:79]
    s_mov_b32 s84, 4227072
    s_add_u32 m0, s83, 49152
    s_nop 0
    buffer_load_dwordx4 v8, s[4:7], s84 offen lds
    ds_read_b64_tr_b16 a[36:37], v33 offset:0
    ds_read_b64_tr_b16 a[38:39], v33 offset:512
    v_mfma_f32_32x32x16_bf16 a[80:95], a[4:7], a[8:11], a[80:95]
    buffer_load_dwordx4 v9, s[4:7], s84 offen offset:1024 lds
    s_mov_b32 s85, 1572864
    s_add_u32 m0, s83, 57344
    s_nop 0
    buffer_load_dwordx4 v10, s[16:19], s85 offen lds
    ds_read_b64_tr_b16 a[40:41], v15 offset:0
    ds_read_b64_tr_b16 a[42:43], v15 offset:512
    v_mfma_f32_32x32x16_bf16 a[96:111], a[4:7], a[12:15], a[96:111]
    buffer_load_dwordx4 v11, s[16:19], s85 offen offset:1024 lds
    ds_read_b64_tr_b16 a[44:45], v35 offset:0
    ds_read_b64_tr_b16 a[46:47], v35 offset:512
    v_mfma_f32_32x32x16_bf16 v[16:31], a[0:3], a[8:11], v[16:31]
    s_mov_b32 s20, s46
    s_and_b32 s21, s47, 0xffff
    s_mov_b32 s22, 0x80000
    s_mov_b32 s23, 0x00020000
    s_mov_b32 s24, s48
    s_and_b32 s25, s49, 0xffff
    s_mov_b32 s26, 0x80000
    s_mov_b32 s27, 0x00020000
    s_mov_b32 s28, s60
    s_and_b32 s29, s61, 0xffff
    s_mov_b32 s30, 0x560000
    s_mov_b32 s31, 0x00020000
    s_mov_b32 s32, s66
    s_and_b32 s33, s67, 0xffff
    s_mov_b32 s34, 0x400000
    s_mov_b32 s35, 0x00020000
    s_waitcnt vmcnt(28)
    s_barrier
    s_cmp_lg_u32 s3, 0
    s_cbranch_scc1 F_HBFL
    s_mov_b64 exec, 1
    buffer_store_dword v250, v243, s[16:19], s99 offen sc1
    s_mov_b64 exec, -1
    F_HBFL:
    ds_read_b64_tr_b16 a[0:1], v13 offset:16384
    ds_read_b64_tr_b16 a[2:3], v13 offset:16896
    s_waitcnt lgkmcnt(2)
    v_mfma_f32_32x32x16_bf16 a[64:79], a[32:35], a[44:47], a[64:79]
    s_mov_b32 s84, 4403200
    s_add_u32 m0, s83, 65536
    s_nop 0
    buffer_load_dwordx4 v8, s[4:7], s84 offen lds
    ds_read_b64_tr_b16 a[4:5], v33 offset:16384
    ds_read_b64_tr_b16 a[6:7], v33 offset:16896
    v_mfma_f32_32x32x16_bf16 a[80:95], a[36:39], a[40:43], a[80:95]
    buffer_load_dwordx4 v9, s[4:7], s84 offen offset:1024 lds
    s_mov_b32 s85, 1638400
    s_add_u32 m0, s83, 73728
    s_nop 0
    buffer_load_dwordx4 v10, s[16:19], s85 offen lds
    ds_read_b64_tr_b16 a[8:9], v15 offset:16384
    ds_read_b64_tr_b16 a[10:11], v15 offset:16896
    v_mfma_f32_32x32x16_bf16 a[96:111], a[36:39], a[44:47], a[96:111]
    buffer_load_dwordx4 v11, s[16:19], s85 offen offset:1024 lds
    ds_read_b64_tr_b16 a[12:13], v35 offset:16384
    ds_read_b64_tr_b16 a[14:15], v35 offset:16896
    v_mfma_f32_32x32x16_bf16 v[16:31], a[32:35], a[40:43], v[16:31]
    s_waitcnt vmcnt(28)
    ds_read_b64_tr_b16 a[32:33], v13 offset:32768
    ds_read_b64_tr_b16 a[34:35], v13 offset:33280
    s_waitcnt lgkmcnt(2)
    v_mfma_f32_32x32x16_bf16 a[64:79], a[0:3], a[12:15], a[64:79]
    s_mov_b32 s84, 4579328
    s_add_u32 m0, s83, 81920
    s_nop 0
    buffer_load_dwordx4 v8, s[4:7], s84 offen lds
    ds_read_b64_tr_b16 a[36:37], v33 offset:32768
    ds_read_b64_tr_b16 a[38:39], v33 offset:33280
    v_mfma_f32_32x32x16_bf16 a[80:95], a[4:7], a[8:11], a[80:95]
    buffer_load_dwordx4 v9, s[4:7], s84 offen offset:1024 lds
    s_mov_b32 s85, 1703936
    s_add_u32 m0, s83, 90112
    s_nop 0
    buffer_load_dwordx4 v10, s[16:19], s85 offen lds
    ds_read_b64_tr_b16 a[40:41], v15 offset:32768
    ds_read_b64_tr_b16 a[42:43], v15 offset:33280
    v_mfma_f32_32x32x16_bf16 a[96:111], a[4:7], a[12:15], a[96:111]
    buffer_load_dwordx4 v11, s[16:19], s85 offen offset:1024 lds
    ds_read_b64_tr_b16 a[44:45], v35 offset:32768
    ds_read_b64_tr_b16 a[46:47], v35 offset:33280
    v_mfma_f32_32x32x16_bf16 v[16:31], a[0:3], a[8:11], v[16:31]
    s_waitcnt vmcnt(24)
    ds_read_b64_tr_b16 a[0:1], v13 offset:49152
    ds_read_b64_tr_b16 a[2:3], v13 offset:49664
    s_waitcnt lgkmcnt(2)
    v_mfma_f32_32x32x16_bf16 a[64:79], a[32:35], a[44:47], a[64:79]
    s_mov_b32 s84, 4755456
    s_add_u32 m0, s83, 98304
    s_nop 0
    buffer_load_dwordx4 v8, s[4:7], s84 offen lds
    ds_read_b64_tr_b16 a[4:5], v33 offset:49152
    ds_read_b64_tr_b16 a[6:7], v33 offset:49664
    v_mfma_f32_32x32x16_bf16 a[80:95], a[36:39], a[40:43], a[80:95]
    buffer_load_dwordx4 v9, s[4:7], s84 offen offset:1024 lds
    s_mov_b32 s85, 1769472
    s_add_u32 m0, s83, 106496
    s_nop 0
    buffer_load_dwordx4 v10, s[16:19], s85 offen lds
    ds_read_b64_tr_b16 a[8:9], v15 offset:49152
    ds_read_b64_tr_b16 a[10:11], v15 offset:49664
    v_mfma_f32_32x32x16_bf16 a[96:111], a[36:39], a[44:47], a[96:111]
    buffer_load_dwordx4 v11, s[16:19], s85 offen offset:1024 lds
    ds_read_b64_tr_b16 a[12:13], v35 offset:49152
    ds_read_b64_tr_b16 a[14:15], v35 offset:49664
    v_mfma_f32_32x32x16_bf16 v[16:31], a[32:35], a[40:43], v[16:31]
    s_waitcnt vmcnt(24)
    ds_read_b64_tr_b16 a[32:33], v12 offset:0
    ds_read_b64_tr_b16 a[34:35], v12 offset:512
    s_waitcnt lgkmcnt(2)
    v_mfma_f32_32x32x16_bf16 a[64:79], a[0:3], a[12:15], a[64:79]
    s_mov_b32 s84, 4931584
    s_add_u32 m0, s83, 114688
    s_nop 0
    buffer_load_dwordx4 v8, s[4:7], s84 offen lds
    ds_read_b64_tr_b16 a[36:37], v32 offset:0
    ds_read_b64_tr_b16 a[38:39], v32 offset:512
    v_mfma_f32_32x32x16_bf16 a[80:95], a[4:7], a[8:11], a[80:95]
    buffer_load_dwordx4 v9, s[4:7], s84 offen offset:1024 lds
    s_mov_b32 s85, 1835008
    s_add_u32 m0, s83, 122880
    s_nop 0
    buffer_load_dwordx4 v10, s[16:19], s85 offen lds
    ds_read_b64_tr_b16 a[40:41], v14 offset:0
    ds_read_b64_tr_b16 a[42:43], v14 offset:512
    v_mfma_f32_32x32x16_bf16 a[96:111], a[4:7], a[12:15], a[96:111]
    buffer_load_dwordx4 v11, s[16:19], s85 offen offset:1024 lds
    ds_read_b64_tr_b16 a[44:45], v34 offset:0
    ds_read_b64_tr_b16 a[46:47], v34 offset:512
    v_mfma_f32_32x32x16_bf16 v[16:31], a[0:3], a[8:11], v[16:31]
    s_waitcnt vmcnt(24)
    ds_read_b64_tr_b16 a[0:1], v12 offset:16384
    ds_read_b64_tr_b16 a[2:3], v12 offset:16896
    s_waitcnt lgkmcnt(2)
    v_mfma_f32_32x32x16_bf16 a[64:79], a[32:35], a[44:47], a[64:79]
    s_mov_b32 s84, 5107712
    s_add_u32 m0, s83, 0
    s_nop 0
    buffer_load_dwordx4 v8, s[4:7], s84 offen lds
    ds_read_b64_tr_b16 a[4:5], v32 offset:16384
    ds_read_b64_tr_b16 a[6:7], v32 offset:16896
    v_mfma_f32_32x32x16_bf16 a[80:95], a[36:39], a[40:43], a[80:95]
    buffer_load_dwordx4 v9, s[4:7], s84 offen offset:1024 lds
    s_mov_b32 s85, 1900544
    s_add_u32 m0, s83, 8192
    s_nop 0
    buffer_load_dwordx4 v10, s[16:19], s85 offen lds
    ds_read_b64_tr_b16 a[8:9], v14 offset:16384
    ds_read_b64_tr_b16 a[10:11], v14 offset:16896
    v_mfma_f32_32x32x16_bf16 a[96:111], a[36:39], a[44:47], a[96:111]
    buffer_load_dwordx4 v11, s[16:19], s85 offen offset:1024 lds
    ds_read_b64_tr_b16 a[12:13], v34 offset:16384
    ds_read_b64_tr_b16 a[14:15], v34 offset:16896
    v_mfma_f32_32x32x16_bf16 v[16:31], a[32:35], a[40:43], v[16:31]
    s_waitcnt vmcnt(24)
    ds_read_b64_tr_b16 a[32:33], v12 offset:32768
    ds_read_b64_tr_b16 a[34:35], v12 offset:33280
    s_waitcnt lgkmcnt(2)
    v_mfma_f32_32x32x16_bf16 a[64:79], a[0:3], a[12:15], a[64:79]
    s_mov_b32 s84, 5283840
    s_add_u32 m0, s83, 16384
    s_nop 0
    buffer_load_dwordx4 v8, s[4:7], s84 offen lds
    ds_read_b64_tr_b16 a[36:37], v32 offset:32768
    ds_read_b64_tr_b16 a[38:39], v32 offset:33280
    v_mfma_f32_32x32x16_bf16 a[80:95], a[4:7], a[8:11], a[80:95]
    buffer_load_dwordx4 v9, s[4:7], s84 offen offset:1024 lds
    s_mov_b32 s85, 1966080
    s_add_u32 m0, s83, 24576
    s_nop 0
    buffer_load_dwordx4 v10, s[16:19], s85 offen lds
    ds_read_b64_tr_b16 a[40:41], v14 offset:32768
    ds_read_b64_tr_b16 a[42:43], v14 offset:33280
    v_mfma_f32_32x32x16_bf16 a[96:111], a[4:7], a[12:15], a[96:111]
    buffer_load_dwordx4 v11, s[16:19], s85 offen offset:1024 lds
    ds_read_b64_tr_b16 a[44:45], v34 offset:32768
    ds_read_b64_tr_b16 a[46:47], v34 offset:33280
    v_mfma_f32_32x32x16_bf16 v[16:31], a[0:3], a[8:11], v[16:31]
    s_waitcnt vmcnt(24)
    ds_read_b64_tr_b16 a[0:1], v12 offset:49152
    ds_read_b64_tr_b16 a[2:3], v12 offset:49664
    s_waitcnt lgkmcnt(2)
    v_mfma_f32_32x32x16_bf16 a[64:79], a[32:35], a[44:47], a[64:79]
    s_mov_b32 s84, 5459968
    s_add_u32 m0, s83, 32768
    s_nop 0
    buffer_load_dwordx4 v8, s[4:7], s84 offen lds
    ds_read_b64_tr_b16 a[4:5], v32 offset:49152
    ds_read_b64_tr_b16 a[6:7], v32 offset:49664
    v_mfma_f32_32x32x16_bf16 a[80:95], a[36:39], a[40:43], a[80:95]
    buffer_load_dwordx4 v9, s[4:7], s84 offen offset:1024 lds
    s_mov_b32 s85, 2031616
    s_add_u32 m0, s83, 40960
    s_nop 0
    buffer_load_dwordx4 v10, s[16:19], s85 offen lds
    ds_read_b64_tr_b16 a[8:9], v14 offset:49152
    ds_read_b64_tr_b16 a[10:11], v14 offset:49664
    v_mfma_f32_32x32x16_bf16 a[96:111], a[36:39], a[44:47], a[96:111]
    buffer_load_dwordx4 v11, s[16:19], s85 offen offset:1024 lds
    ds_read_b64_tr_b16 a[12:13], v34 offset:49152
    ds_read_b64_tr_b16 a[14:15], v34 offset:49664
    v_mfma_f32_32x32x16_bf16 v[16:31], a[32:35], a[40:43], v[16:31]
    s_waitcnt vmcnt(24)
    ds_read_b64_tr_b16 a[32:33], v13 offset:0
    ds_read_b64_tr_b16 a[34:35], v13 offset:512
    s_waitcnt lgkmcnt(2)
    v_mfma_f32_32x32x16_bf16 a[64:79], a[0:3], a[12:15], a[64:79]
    ds_read_b64_tr_b16 a[36:37], v33 offset:0
    ds_read_b64_tr_b16 a[38:39], v33 offset:512
    v_mfma_f32_32x32x16_bf16 a[80:95], a[4:7], a[8:11], a[80:95]
    ds_read_b64_tr_b16 a[40:41], v15 offset:0
    ds_read_b64_tr_b16 a[42:43], v15 offset:512
    v_mfma_f32_32x32x16_bf16 a[96:111], a[4:7], a[12:15], a[96:111]
    ds_read_b64_tr_b16 a[44:45], v35 offset:0
    ds_read_b64_tr_b16 a[46:47], v35 offset:512
    v_mfma_f32_32x32x16_bf16 v[16:31], a[0:3], a[8:11], v[16:31]
    s_waitcnt vmcnt(20)
    s_mov_b32 s84, 0
    s_add_u32 m0, s83, 49152
    s_nop 0
    buffer_load_dwordx4 v200, s[20:23], s84 offen lds
    ds_read_b64_tr_b16 a[0:1], v13 offset:16384
    ds_read_b64_tr_b16 a[2:3], v13 offset:16896
    s_waitcnt lgkmcnt(2)
    v_mfma_f32_32x32x16_bf16 a[64:79], a[32:35], a[44:47], a[64:79]
    buffer_load_dwordx4 v201, s[20:23], s84 offen offset:1024 lds
    ds_read_b64_tr_b16 a[4:5], v33 offset:16384
    ds_read_b64_tr_b16 a[6:7], v33 offset:16896
    v_mfma_f32_32x32x16_bf16 a[80:95], a[36:39], a[40:43], a[80:95]
    ds_read_b64_tr_b16 a[8:9], v15 offset:16384
    ds_read_b64_tr_b16 a[10:11], v15 offset:16896
    v_mfma_f32_32x32x16_bf16 a[96:111], a[36:39], a[44:47], a[96:111]
    ds_read_b64_tr_b16 a[12:13], v35 offset:16384
    ds_read_b64_tr_b16 a[14:15], v35 offset:16896
    v_mfma_f32_32x32x16_bf16 v[16:31], a[32:35], a[40:43], v[16:31]
    buffer_load_dword v227, v226, s[16:19], s97 offen sc1
    s_waitcnt vmcnt(19)
    s_mov_b32 s84, 0
    s_add_u32 m0, s83, 65536
    s_nop 0
    buffer_load_dwordx4 v200, s[24:27], s84 offen lds
    ds_read_b64_tr_b16 a[32:33], v13 offset:32768
    ds_read_b64_tr_b16 a[34:35], v13 offset:33280
    s_waitcnt lgkmcnt(2)
    v_mfma_f32_32x32x16_bf16 a[64:79], a[0:3], a[12:15], a[64:79]
    buffer_load_dwordx4 v201, s[24:27], s84 offen offset:1024 lds
    ds_read_b64_tr_b16 a[36:37], v33 offset:32768
    ds_read_b64_tr_b16 a[38:39], v33 offset:33280
    v_mfma_f32_32x32x16_bf16 a[80:95], a[4:7], a[8:11], a[80:95]
    ds_read_b64_tr_b16 a[40:41], v15 offset:32768
    ds_read_b64_tr_b16 a[42:43], v15 offset:33280
    v_mfma_f32_32x32x16_bf16 a[96:111], a[4:7], a[12:15], a[96:111]
    ds_read_b64_tr_b16 a[44:45], v35 offset:32768
    ds_read_b64_tr_b16 a[46:47], v35 offset:33280
    v_mfma_f32_32x32x16_bf16 v[16:31], a[0:3], a[8:11], v[16:31]
    s_waitcnt vmcnt(17)
    s_mov_b32 s84, 128
    s_add_u32 m0, s83, 81920
    s_nop 0
    buffer_load_dwordx4 v200, s[20:23], s84 offen lds
    ds_read_b64_tr_b16 a[0:1], v13 offset:49152
    ds_read_b64_tr_b16 a[2:3], v13 offset:49664
    s_waitcnt lgkmcnt(2)
    v_mfma_f32_32x32x16_bf16 a[64:79], a[32:35], a[44:47], a[64:79]
    buffer_load_dwordx4 v201, s[20:23], s84 offen offset:1024 lds
    ds_read_b64_tr_b16 a[4:5], v33 offset:49152
    ds_read_b64_tr_b16 a[6:7], v33 offset:49664
    v_mfma_f32_32x32x16_bf16 a[80:95], a[36:39], a[40:43], a[80:95]
    ds_read_b64_tr_b16 a[8:9], v15 offset:49152
    ds_read_b64_tr_b16 a[10:11], v15 offset:49664
    v_mfma_f32_32x32x16_bf16 a[96:111], a[36:39], a[44:47], a[96:111]
    ds_read_b64_tr_b16 a[12:13], v35 offset:49152
    ds_read_b64_tr_b16 a[14:15], v35 offset:49664
    v_mfma_f32_32x32x16_bf16 v[16:31], a[32:35], a[40:43], v[16:31]
    s_waitcnt vmcnt(15)
    s_mov_b32 s84, 128
    s_add_u32 m0, s83, 98304
    s_nop 0
    buffer_load_dwordx4 v200, s[24:27], s84 offen lds
    ds_read_b64_tr_b16 a[32:33], v12 offset:0
    ds_read_b64_tr_b16 a[34:35], v12 offset:512
    s_waitcnt lgkmcnt(2)
    v_mfma_f32_32x32x16_bf16 a[64:79], a[0:3], a[12:15], a[64:79]
    buffer_load_dwordx4 v201, s[24:27], s84 offen offset:1024 lds
    ds_read_b64_tr_b16 a[36:37], v32 offset:0
    ds_read_b64_tr_b16 a[38:39], v32 offset:512
    v_mfma_f32_32x32x16_bf16 a[80:95], a[4:7], a[8:11], a[80:95]
    ds_read_b64_tr_b16 a[40:41], v14 offset:0
    ds_read_b64_tr_b16 a[42:43], v14 offset:512
    v_mfma_f32_32x32x16_bf16 a[96:111], a[4:7], a[12:15], a[96:111]
    ds_read_b64_tr_b16 a[44:45], v34 offset:0
    ds_read_b64_tr_b16 a[46:47], v34 offset:512
    v_mfma_f32_32x32x16_bf16 v[16:31], a[0:3], a[8:11], v[16:31]
    v_lshlrev_b32 v64, 16, v128
    v_and_b32 v65, 0xffff0000, v128
    v_lshlrev_b32 v66, 16, v129
    v_and_b32 v67, 0xffff0000, v129
    v_lshlrev_b32 v68, 16, v130
    v_and_b32 v69, 0xffff0000, v130
    v_lshlrev_b32 v70, 16, v131
    v_and_b32 v71, 0xffff0000, v131
    v_lshlrev_b32 v72, 16, v132
    v_and_b32 v73, 0xffff0000, v132
    v_lshlrev_b32 v74, 16, v133
    v_and_b32 v75, 0xffff0000, v133
    v_lshlrev_b32 v76, 16, v134
    v_and_b32 v77, 0xffff0000, v134
    v_lshlrev_b32 v78, 16, v135
    v_and_b32 v79, 0xffff0000, v135
    v_mov_b32 v104, 0xbdd2d3e8
    v_mov_b32 v105, 0xc0135761
    v_mov_b32 v106, 1.0
    s_waitcnt vmcnt(13)
    s_waitcnt vmcnt(6)
HBCHKF:
    v_cmp_ne_u32 vcc, v250, v227
    s_cbranch_vccz HBOKF
    s_cmp_eq_u32 s96, 0
    s_cbranch_scc1 HBOKF
    s_sub_u32 s96, s96, 1
    s_sleep 1
    buffer_load_dword v227, v226, s[16:19], s97 offen sc1
    s_waitcnt vmcnt(0)
    s_branch HBCHKF
HBOKF:
    s_mov_b32 s85, 0
    s_add_u32 m0, s83, 57344
    s_nop 0
    buffer_load_dwordx4 v202, s[16:19], s85 offen lds
    buffer_load_dwordx4 v203, s[16:19], s85 offen offset:1024 lds
    s_mov_b32 s85, 64
    s_add_u32 m0, s83, 73728
    s_nop 0
    buffer_load_dwordx4 v202, s[16:19], s85 offen lds
    buffer_load_dwordx4 v203, s[16:19], s85 offen offset:1024 lds
    s_mov_b32 s85, 256
    s_add_u32 m0, s83, 90112
    s_nop 0
    buffer_load_dwordx4 v202, s[16:19], s85 offen lds
    buffer_load_dwordx4 v203, s[16:19], s85 offen offset:1024 lds
    s_mov_b32 s85, 320
    s_add_u32 m0, s83, 106496
    s_nop 0
    buffer_load_dwordx4 v202, s[16:19], s85 offen lds
    buffer_load_dwordx4 v203, s[16:19], s85 offen offset:1024 lds
    s_mov_b32 s84, 256
    s_add_u32 m0, s83, 114688
    s_nop 0
    buffer_load_dwordx4 v200, s[20:23], s84 offen lds
    ds_read_b64_tr_b16 a[0:1], v12 offset:16384
    ds_read_b64_tr_b16 a[2:3], v12 offset:16896
    s_waitcnt lgkmcnt(2)
    v_mfma_f32_32x32x16_bf16 a[64:79], a[32:35], a[44:47], a[64:79]
    buffer_load_dwordx4 v201, s[20:23], s84 offen offset:1024 lds
    ds_read_b64_tr_b16 a[4:5], v32 offset:16384
    ds_read_b64_tr_b16 a[6:7], v32 offset:16896
    v_mfma_f32_32x32x16_bf16 a[80:95], a[36:39], a[40:43], a[80:95]
    s_mov_b32 s85, 512
    s_add_u32 m0, s83, 122880
    s_nop 0
    buffer_load_dwordx4 v202, s[16:19], s85 offen lds
    ds_read_b64_tr_b16 a[8:9], v14 offset:16384
    ds_read_b64_tr_b16 a[10:11], v14 offset:16896
    v_mfma_f32_32x32x16_bf16 a[96:111], a[36:39], a[44:47], a[96:111]
    buffer_load_dwordx4 v203, s[16:19], s85 offen offset:1024 lds
    ds_read_b64_tr_b16 a[12:13], v34 offset:16384
    ds_read_b64_tr_b16 a[14:15], v34 offset:16896
    v_mfma_f32_32x32x16_bf16 v[16:31], a[32:35], a[40:43], v[16:31]
    v_lshlrev_b32 v152, 4, v1
    s_lshl_b32 s86, s3, 12
    s_add_u32 s86, s86, 131072
    v_add_u32 v153, s86, v152
    v_add_u32 v152, s83, v152
    v_xor_b32 v154, 2048, v152
    v_xor_b32 v155, 4096, v152
    v_xor_b32 v156, 12288, v153
    s_xor_b32 s86, s86, 12288
    v_and_b32 v157, 31, v1
    v_mul_u32_u24 v157, 80, v157
    v_lshrrev_b32 v158, 5, v1
    v_lshl_add_u32 v157, v158, 3, v157
    v_add_u32 v157, s86, v157
    v_lshrrev_b32 v158, 2, v1
    v_mul_u32_u24 v158, 80, v158
    v_and_b32 v159, 3, v1
    v_lshl_add_u32 v158, v159, 4, v158
    v_add_u32 v158, s86, v158
    s_mov_b32 s84, 256
    s_add_u32 m0, s83, 0
    s_nop 0
    buffer_load_dwordx4 v200, s[24:27], s84 offen lds
    ds_read_b64_tr_b16 a[32:33], v12 offset:32768
    ds_read_b64_tr_b16 a[34:35], v12 offset:33280
    s_waitcnt lgkmcnt(2)
    v_mfma_f32_32x32x16_bf16 a[64:79], a[0:3], a[12:15], a[64:79]
    buffer_load_dwordx4 v201, s[24:27], s84 offen offset:1024 lds
    ds_read_b64_tr_b16 a[36:37], v32 offset:32768
    ds_read_b64_tr_b16 a[38:39], v32 offset:33280
    v_mfma_f32_32x32x16_bf16 a[80:95], a[4:7], a[8:11], a[80:95]
    s_mov_b32 s85, 576
    s_add_u32 m0, s83, 8192
    s_nop 0
    buffer_load_dwordx4 v202, s[16:19], s85 offen lds
    ds_read_b64_tr_b16 a[40:41], v14 offset:32768
    ds_read_b64_tr_b16 a[42:43], v14 offset:33280
    v_mfma_f32_32x32x16_bf16 a[96:111], a[4:7], a[12:15], a[96:111]
    buffer_load_dwordx4 v203, s[16:19], s85 offen offset:1024 lds
    ds_read_b64_tr_b16 a[44:45], v34 offset:32768
    ds_read_b64_tr_b16 a[46:47], v34 offset:33280
    v_mfma_f32_32x32x16_bf16 v[16:31], a[0:3], a[8:11], v[16:31]
    s_waitcnt lgkmcnt(0)
    v_mfma_f32_32x32x16_bf16 a[64:79], a[32:35], a[44:47], a[64:79]
    buffer_load_dword v231, v230, s[16:19], 0 offen
    v_mfma_f32_32x32x16_bf16 a[80:95], a[36:39], a[40:43], a[80:95]
    v_mfma_f32_32x32x16_bf16 a[96:111], a[36:39], a[44:47], a[96:111]
    s_nop 3
    ds_write_b128 v152, a[64:67] offset:16384
    ds_write_b128 v152, a[68:71] offset:17408
    ds_write_b128 v152, a[72:75] offset:24576
    ds_write_b128 v152, a[76:79] offset:25600
    v_mfma_f32_32x32x16_bf16 v[16:31], a[32:35], a[40:43], v[16:31]
    ds_write_b128 v152, a[80:83] offset:32768
    ds_write_b128 v152, a[84:87] offset:33792
    ds_write_b128 v152, a[88:91] offset:40960
    ds_write_b128 v152, a[92:95] offset:41984
    ds_write_b128 v153, a[96:99] offset:0
    ds_write_b128 v153, a[100:103] offset:1024
    ds_write_b128 v153, a[104:107] offset:2048
    ds_write_b128 v153, a[108:111] offset:3072
    s_waitcnt lgkmcnt(0)
    s_barrier
    ds_read_b128 v[136:139], v154 offset:16384
    ds_read_b128 v[140:143], v154 offset:17408
    ds_read_b128 v[144:147], v154 offset:24576
    ds_read_b128 v[148:151], v154 offset:25600
    ds_read_b128 v[112:115], v155 offset:32768
    ds_read_b128 v[116:119], v155 offset:33792
    ds_read_b128 v[120:123], v155 offset:40960
    ds_read_b128 v[124:127], v155 offset:41984
    ds_read_b128 v[80:83], v156 offset:0
    ds_read_b128 v[84:87], v156 offset:1024
    ds_read_b128 v[88:91], v156 offset:2048
    ds_read_b128 v[92:95], v156 offset:3072
F_RR:
    s_waitcnt lgkmcnt(8)
    v_pk_add_f32 v[16:17], v[16:17], v[136:137]
    v_pk_add_f32 v[18:19], v[18:19], v[138:139]
    v_pk_add_f32 v[20:21], v[20:21], v[140:141]
    v_pk_add_f32 v[22:23], v[22:23], v[142:143]
    v_pk_add_f32 v[24:25], v[24:25], v[144:145]
    v_pk_add_f32 v[26:27], v[26:27], v[146:147]
    v_pk_add_f32 v[28:29], v[28:29], v[148:149]
    v_pk_add_f32 v[30:31], v[30:31], v[150:151]
    s_waitcnt lgkmcnt(4)
    v_pk_add_f32 v[16:17], v[16:17], v[112:113]
    v_pk_add_f32 v[18:19], v[18:19], v[114:115]
    v_pk_add_f32 v[20:21], v[20:21], v[116:117]
    v_pk_add_f32 v[22:23], v[22:23], v[118:119]
    v_pk_add_f32 v[24:25], v[24:25], v[120:121]
    v_pk_add_f32 v[26:27], v[26:27], v[122:123]
    v_pk_add_f32 v[28:29], v[28:29], v[124:125]
    v_pk_add_f32 v[30:31], v[30:31], v[126:127]
    s_waitcnt lgkmcnt(0)
    v_pk_add_f32 v[16:17], v[16:17], v[80:81]
    v_pk_add_f32 v[18:19], v[18:19], v[82:83]
    v_pk_add_f32 v[20:21], v[20:21], v[84:85]
    v_pk_add_f32 v[22:23], v[22:23], v[86:87]
    v_pk_add_f32 v[24:25], v[24:25], v[88:89]
    v_pk_add_f32 v[26:27], v[26:27], v[90:91]
    v_pk_add_f32 v[28:29], v[28:29], v[92:93]
    v_pk_add_f32 v[30:31], v[30:31], v[94:95]
    v_cvt_pk_bf16_f32 v80, v16, v17
    v_lshlrev_b32 v16, 16, v80
    v_and_b32 v17, 0xffff0000, v80
    v_cvt_pk_bf16_f32 v82, v18, v19
    v_lshlrev_b32 v18, 16, v82
    v_and_b32 v19, 0xffff0000, v82
    v_cvt_pk_bf16_f32 v84, v20, v21
    v_lshlrev_b32 v20, 16, v84
    v_and_b32 v21, 0xffff0000, v84
    v_cvt_pk_bf16_f32 v86, v22, v23
    v_lshlrev_b32 v22, 16, v86
    v_and_b32 v23, 0xffff0000, v86
    v_cvt_pk_bf16_f32 v88, v24, v25
    v_lshlrev_b32 v24, 16, v88
    v_and_b32 v25, 0xffff0000, v88
    v_cvt_pk_bf16_f32 v90, v26, v27
    v_lshlrev_b32 v26, 16, v90
    v_and_b32 v27, 0xffff0000, v90
    v_cvt_pk_bf16_f32 v92, v28, v29
    v_lshlrev_b32 v28, 16, v92
    v_and_b32 v29, 0xffff0000, v92
    v_cvt_pk_bf16_f32 v94, v30, v31
    v_lshlrev_b32 v30, 16, v94
    v_and_b32 v31, 0xffff0000, v94
    v_pk_add_f32 v[16:17], v[16:17], v[64:65]
    v_pk_add_f32 v[18:19], v[18:19], v[66:67]
    v_pk_add_f32 v[20:21], v[20:21], v[68:69]
    v_pk_add_f32 v[22:23], v[22:23], v[70:71]
    v_pk_add_f32 v[24:25], v[24:25], v[72:73]
    v_pk_add_f32 v[26:27], v[26:27], v[74:75]
    v_pk_add_f32 v[28:29], v[28:29], v[76:77]
    v_pk_add_f32 v[30:31], v[30:31], v[78:79]
    v_cvt_pk_bf16_f32 v80, v16, v17
    v_lshlrev_b32 v16, 16, v80
    v_and_b32 v17, 0xffff0000, v80
    v_cvt_pk_bf16_f32 v82, v18, v19
    v_lshlrev_b32 v18, 16, v82
    v_and_b32 v19, 0xffff0000, v82
    v_cvt_pk_bf16_f32 v84, v20, v21
    v_lshlrev_b32 v20, 16, v84
    v_and_b32 v21, 0xffff0000, v84
    v_cvt_pk_bf16_f32 v86, v22, v23
    v_lshlrev_b32 v22, 16, v86
    v_and_b32 v23, 0xffff0000, v86
    v_cvt_pk_bf16_f32 v88, v24, v25
    v_lshlrev_b32 v24, 16, v88
    v_and_b32 v25, 0xffff0000, v88
    v_cvt_pk_bf16_f32 v90, v26, v27
    v_lshlrev_b32 v26, 16, v90
    v_and_b32 v27, 0xffff0000, v90
    v_cvt_pk_bf16_f32 v92, v28, v29
    v_lshlrev_b32 v28, 16, v92
    v_and_b32 v29, 0xffff0000, v92
    v_cvt_pk_bf16_f32 v94, v30, v31
    v_lshlrev_b32 v30, 16, v94
    v_and_b32 v31, 0xffff0000, v94
    v_pk_mul_f32 v[80:81], v[16:17], v[16:17]
    v_pk_mul_f32 v[82:83], v[18:19], v[18:19]
    v_pk_mul_f32 v[84:85], v[20:21], v[20:21]
    v_pk_mul_f32 v[86:87], v[22:23], v[22:23]
    v_pk_mul_f32 v[88:89], v[24:25], v[24:25]
    v_pk_mul_f32 v[90:91], v[26:27], v[26:27]
    v_pk_mul_f32 v[92:93], v[28:29], v[28:29]
    v_pk_mul_f32 v[94:95], v[30:31], v[30:31]
    v_pk_fma_f32 v[80:81], v[80:81], v[104:105], v[104:105] op_sel:[0,0,1] op_sel_hi:[1,0,1]
    v_pk_fma_f32 v[82:83], v[82:83], v[104:105], v[104:105] op_sel:[0,0,1] op_sel_hi:[1,0,1]
    v_pk_fma_f32 v[84:85], v[84:85], v[104:105], v[104:105] op_sel:[0,0,1] op_sel_hi:[1,0,1]
    v_pk_fma_f32 v[86:87], v[86:87], v[104:105], v[104:105] op_sel:[0,0,1] op_sel_hi:[1,0,1]
    v_pk_fma_f32 v[88:89], v[88:89], v[104:105], v[104:105] op_sel:[0,0,1] op_sel_hi:[1,0,1]
    v_pk_fma_f32 v[90:91], v[90:91], v[104:105], v[104:105] op_sel:[0,0,1] op_sel_hi:[1,0,1]
    v_pk_fma_f32 v[92:93], v[92:93], v[104:105], v[104:105] op_sel:[0,0,1] op_sel_hi:[1,0,1]
    v_pk_fma_f32 v[94:95], v[94:95], v[104:105], v[104:105] op_sel:[0,0,1] op_sel_hi:[1,0,1]
    v_pk_mul_f32 v[80:81], v[80:81], v[16:17]
    v_exp_f32 v80, v80
    v_exp_f32 v81, v81
    v_pk_mul_f32 v[82:83], v[82:83], v[18:19]
    v_exp_f32 v82, v82
    v_exp_f32 v83, v83
    v_pk_mul_f32 v[84:85], v[84:85], v[20:21]
    v_exp_f32 v84, v84
    v_exp_f32 v85, v85
    v_pk_mul_f32 v[86:87], v[86:87], v[22:23]
    v_exp_f32 v86, v86
    v_exp_f32 v87, v87
    v_pk_mul_f32 v[88:89], v[88:89], v[24:25]
    v_exp_f32 v88, v88
    v_exp_f32 v89, v89
    v_pk_mul_f32 v[90:91], v[90:91], v[26:27]
    v_exp_f32 v90, v90
    v_exp_f32 v91, v91
    v_pk_mul_f32 v[92:93], v[92:93], v[28:29]
    v_exp_f32 v92, v92
    v_exp_f32 v93, v93
    v_pk_mul_f32 v[94:95], v[94:95], v[30:31]
    v_exp_f32 v94, v94
    v_exp_f32 v95, v95
    v_pk_add_f32 v[80:81], v[80:81], v[106:107] op_sel_hi:[1,0]
    v_rcp_f32 v80, v80
    v_rcp_f32 v81, v81
    v_pk_add_f32 v[82:83], v[82:83], v[106:107] op_sel_hi:[1,0]
    v_rcp_f32 v82, v82
    v_rcp_f32 v83, v83
    v_pk_add_f32 v[84:85], v[84:85], v[106:107] op_sel_hi:[1,0]
    v_rcp_f32 v84, v84
    v_rcp_f32 v85, v85
    v_pk_add_f32 v[86:87], v[86:87], v[106:107] op_sel_hi:[1,0]
    v_rcp_f32 v86, v86
    v_rcp_f32 v87, v87
    v_pk_add_f32 v[88:89], v[88:89], v[106:107] op_sel_hi:[1,0]
    v_rcp_f32 v88, v88
    v_rcp_f32 v89, v89
    v_pk_add_f32 v[90:91], v[90:91], v[106:107] op_sel_hi:[1,0]
    v_rcp_f32 v90, v90
    v_rcp_f32 v91, v91
    v_pk_add_f32 v[92:93], v[92:93], v[106:107] op_sel_hi:[1,0]
    v_rcp_f32 v92, v92
    v_rcp_f32 v93, v93
    v_pk_add_f32 v[94:95], v[94:95], v[106:107] op_sel_hi:[1,0]
    v_rcp_f32 v94, v94
    v_rcp_f32 v95, v95
    s_mov_b32 s90, 20971520
    v_pk_mul_f32 v[16:17], v[16:17], v[80:81]
    v_pk_mul_f32 v[18:19], v[18:19], v[82:83]
    v_pk_mul_f32 v[20:21], v[20:21], v[84:85]
    v_pk_mul_f32 v[22:23], v[22:23], v[86:87]
    v_pk_mul_f32 v[24:25], v[24:25], v[88:89]
    v_pk_mul_f32 v[26:27], v[26:27], v[90:91]
    v_pk_mul_f32 v[28:29], v[28:29], v[92:93]
    v_pk_mul_f32 v[30:31], v[30:31], v[94:95]
    v_cvt_pk_bf16_f32 v96, v16, v17
    v_cvt_pk_bf16_f32 v97, v18, v19
    v_cvt_pk_bf16_f32 v98, v20, v21
    v_cvt_pk_bf16_f32 v99, v22, v23
    v_cvt_pk_bf16_f32 v100, v24, v25
    v_cvt_pk_bf16_f32 v101, v26, v27
    v_cvt_pk_bf16_f32 v102, v28, v29
    v_cvt_pk_bf16_f32 v103, v30, v31
    s_cmp_lt_u32 s93, 1376
    s_cbranch_scc1 F_ST
    v_mov_b32 v96, 0
    v_mov_b32 v97, 0
    v_mov_b32 v98, 0
    v_mov_b32 v99, 0
    v_mov_b32 v100, 0
    v_mov_b32 v101, 0
    v_mov_b32 v102, 0
    v_mov_b32 v103, 0
F_ST:
    ds_write_b64 v157, v[96:97] offset:0
    ds_write_b64 v157, v[98:99] offset:16
    ds_write_b64 v157, v[100:101] offset:32
    ds_write_b64 v157, v[102:103] offset:48
    s_mov_b32 s91, 21016576
    s_waitcnt lgkmcnt(0)
    ds_read_b128 v[80:83], v158
    ds_read_b128 v[84:87], v158 offset:1280
    s_waitcnt lgkmcnt(1)
    buffer_store_dwordx4 v[80:83], v199, s[16:19], s90 offen sc1
    s_waitcnt lgkmcnt(0)
    buffer_store_dwordx4 v[84:87], v199, s[16:19], s91 offen sc1
F_EP:
G32:
    s_waitcnt vmcnt(17)
    s_barrier
    s_mov_b32 s84, 384
    s_add_u32 m0, s83, 16384
    s_nop 0
    buffer_load_dwordx4 v200, s[20:23], s84 offen lds
    ds_read_b128 a[0:3], v180 offset:49152
    ds_read_b128 a[16:19], v188 offset:49152
    buffer_load_dwordx4 v201, s[20:23], s84 offen offset:1024 lds
    ds_read_b128 a[4:7], v181 offset:49152
    ds_read_b128 a[20:23], v189 offset:49152
    s_mov_b32 s85, 768
    s_add_u32 m0, s83, 24576
    s_nop 0
    buffer_load_dwordx4 v202, s[16:19], s85 offen lds
    ds_read_b128 a[8:11], v182 offset:49152
    ds_read_b128 a[24:27], v190 offset:49152
    buffer_load_dwordx4 v203, s[16:19], s85 offen offset:1024 lds
    ds_read_b128 a[12:15], v183 offset:49152
    ds_read_b128 a[28:31], v191 offset:49152
    s_waitcnt vmcnt(19)
    s_barrier
    s_mov_b32 s84, 384
    s_add_u32 m0, s83, 32768
    s_nop 0
    buffer_load_dwordx4 v200, s[24:27], s84 offen lds
    ds_read_b128 a[32:35], v184 offset:0
    ds_read_b128 a[48:51], v192 offset:0
    s_waitcnt lgkmcnt(2)
    v_mfma_f32_32x32x16_bf16 v[160:175], a[0:3], a[16:19], 0
    buffer_load_dwordx4 v201, s[24:27], s84 offen offset:1024 lds
    ds_read_b128 a[36:39], v185 offset:0
    ds_read_b128 a[52:55], v193 offset:0
    v_mfma_f32_32x32x16_bf16 v[160:175], a[4:7], a[20:23], v[160:175]
    s_mov_b32 s85, 832
    s_add_u32 m0, s83, 40960
    s_nop 0
    buffer_load_dwordx4 v202, s[16:19], s85 offen lds
    ds_read_b128 a[40:43], v186 offset:0
    ds_read_b128 a[56:59], v194 offset:0
    v_mfma_f32_32x32x16_bf16 v[160:175], a[8:11], a[24:27], v[160:175]
    buffer_load_dwordx4 v203, s[16:19], s85 offen offset:1024 lds
    ds_read_b128 a[44:47], v187 offset:0
    ds_read_b128 a[60:63], v195 offset:0
    v_mfma_f32_32x32x16_bf16 v[160:175], a[12:15], a[28:31], v[160:175]
    s_waitcnt vmcnt(8)
    s_barrier
    s_cmp_lg_u32 s3, 0
    s_cbranch_scc1 P3_UFL
    s_cmp_ge_u32 s101, 22
    s_cbranch_scc1 P3_UFL
    s_mov_b64 exec, 255
    buffer_store_dword v250, v243, s[16:19], s100 offen sc1
    s_mov_b64 exec, -1
    P3_UFL:
    s_mov_b32 s84, 512
    s_add_u32 m0, s83, 49152
    s_nop 0
    buffer_load_dwordx4 v200, s[20:23], s84 offen lds
    ds_read_b128 a[0:3], v184 offset:16384
    ds_read_b128 a[16:19], v192 offset:16384
    s_waitcnt lgkmcnt(2)
    v_mfma_f32_32x32x16_bf16 v[160:175], a[32:35], a[48:51], v[160:175]
    buffer_load_dwordx4 v201, s[20:23], s84 offen offset:1024 lds
    ds_read_b128 a[4:7], v185 offset:16384
    ds_read_b128 a[20:23], v193 offset:16384
    v_mfma_f32_32x32x16_bf16 v[160:175], a[36:39], a[52:55], v[160:175]
    s_mov_b32 s85, 1024
    s_add_u32 m0, s83, 57344
    s_nop 0
    buffer_load_dwordx4 v202, s[16:19], s85 offen lds
    ds_read_b128 a[8:11], v186 offset:16384
    ds_read_b128 a[24:27], v194 offset:16384
    v_mfma_f32_32x32x16_bf16 v[160:175], a[40:43], a[56:59], v[160:175]
    buffer_load_dwordx4 v203, s[16:19], s85 offen offset:1024 lds
    ds_read_b128 a[12:15], v187 offset:16384
    ds_read_b128 a[28:31], v195 offset:16384
    v_mfma_f32_32x32x16_bf16 v[160:175], a[44:47], a[60:63], v[160:175]
    s_barrier
    s_mov_b32 s84, 512
    s_add_u32 m0, s83, 65536
    s_nop 0
    buffer_load_dwordx4 v200, s[24:27], s84 offen lds
    ds_read_b128 a[32:35], v184 offset:32768
    ds_read_b128 a[48:51], v192 offset:32768
    s_waitcnt lgkmcnt(2)
    v_mfma_f32_32x32x16_bf16 v[160:175], a[0:3], a[16:19], v[160:175]
    buffer_load_dwordx4 v201, s[24:27], s84 offen offset:1024 lds
    ds_read_b128 a[36:39], v185 offset:32768
    ds_read_b128 a[52:55], v193 offset:32768
    v_mfma_f32_32x32x16_bf16 v[160:175], a[4:7], a[20:23], v[160:175]
    s_mov_b32 s85, 1088
    s_add_u32 m0, s83, 73728
    s_nop 0
    buffer_load_dwordx4 v202, s[16:19], s85 offen lds
    ds_read_b128 a[40:43], v186 offset:32768
    ds_read_b128 a[56:59], v194 offset:32768
    v_mfma_f32_32x32x16_bf16 v[160:175], a[8:11], a[24:27], v[160:175]
    buffer_load_dwordx4 v203, s[16:19], s85 offen offset:1024 lds
    ds_read_b128 a[44:47], v187 offset:32768
    ds_read_b128 a[60:63], v195 offset:32768
    v_mfma_f32_32x32x16_bf16 v[160:175], a[12:15], a[28:31], v[160:175]
    s_barrier
    s_mov_b32 s84, 640
    s_add_u32 m0, s83, 81920
    s_nop 0
    buffer_load_dwordx4 v200, s[20:23], s84 offen lds
    ds_read_b128 a[0:3], v184 offset:49152
    ds_read_b128 a[16:19], v192 offset:49152
    s_waitcnt lgkmcnt(2)
    v_mfma_f32_32x32x16_bf16 v[160:175], a[32:35], a[48:51], v[160:175]
    buffer_load_dwordx4 v201, s[20:23], s84 offen offset:1024 lds
    ds_read_b128 a[4:7], v185 offset:49152
    ds_read_b128 a[20:23], v193 offset:49152
    v_mfma_f32_32x32x16_bf16 v[160:175], a[36:39], a[52:55], v[160:175]
    s_mov_b32 s85, 1280
    s_add_u32 m0, s83, 90112
    s_nop 0
    buffer_load_dwordx4 v202, s[16:19], s85 offen lds
    ds_read_b128 a[8:11], v186 offset:49152
    ds_read_b128 a[24:27], v194 offset:49152
    v_mfma_f32_32x32x16_bf16 v[160:175], a[40:43], a[56:59], v[160:175]
    buffer_load_dwordx4 v203, s[16:19], s85 offen offset:1024 lds
    ds_read_b128 a[12:15], v187 offset:49152
    ds_read_b128 a[28:31], v195 offset:49152
    v_mfma_f32_32x32x16_bf16 v[160:175], a[44:47], a[60:63], v[160:175]
    s_barrier
    s_mov_b32 s84, 640
    s_add_u32 m0, s83, 98304
    s_nop 0
    buffer_load_dwordx4 v200, s[24:27], s84 offen lds
    ds_read_b128 a[32:35], v180 offset:0
    ds_read_b128 a[48:51], v188 offset:0
    s_waitcnt lgkmcnt(2)
    v_mfma_f32_32x32x16_bf16 v[160:175], a[0:3], a[16:19], v[160:175]
    buffer_load_dwordx4 v201, s[24:27], s84 offen offset:1024 lds
    ds_read_b128 a[36:39], v181 offset:0
    ds_read_b128 a[52:55], v189 offset:0
    v_mfma_f32_32x32x16_bf16 v[160:175], a[4:7], a[20:23], v[160:175]
    s_mov_b32 s85, 1344
    s_add_u32 m0, s83, 106496
    s_nop 0
    buffer_load_dwordx4 v202, s[16:19], s85 offen lds
    ds_read_b128 a[40:43], v182 offset:0
    ds_read_b128 a[56:59], v190 offset:0
    v_mfma_f32_32x32x16_bf16 v[160:175], a[8:11], a[24:27], v[160:175]
    buffer_load_dwordx4 v203, s[16:19], s85 offen offset:1024 lds
    ds_read_b128 a[44:47], v183 offset:0
    ds_read_b128 a[60:63], v191 offset:0
    v_mfma_f32_32x32x16_bf16 v[160:175], a[12:15], a[28:31], v[160:175]
    s_mov_b32 s4, s36
    s_and_b32 s5, s37, 0xffff
    s_mov_b32 s6, 0x200000
    s_mov_b32 s7, 0x00020000
    s_mov_b32 s8, s52
    s_and_b32 s9, s53, 0xffff
    s_mov_b32 s10, 0x400
    s_mov_b32 s11, 0x00020000
    s_mov_b32 s12, s62
    s_and_b32 s13, s63, 0xffff
    s_mov_b32 s14, 0x1000
    s_mov_b32 s15, 0x00020000
    s_mov_b32 s79, 2097152
    buffer_load_dword v224, v176, s[16:19], s79 offen
    buffer_load_ushort v225, v177, s[12:15], 0 offen
    buffer_load_dwordx2 v[120:121], v178, s[8:11], 0 offen offset:0
    buffer_load_dwordx2 v[122:123], v178, s[8:11], 0 offen offset:16
    buffer_load_dwordx2 v[124:125], v178, s[8:11], 0 offen offset:32
    buffer_load_dwordx2 v[126:127], v178, s[8:11], 0 offen offset:48
    s_lshl_b32 s86, s3, 12
    s_add_u32 m0, s86, 131072
    s_mov_b32 s86, 15360
    buffer_load_dwordx4 v179, s[4:7], 0 offen lds
    buffer_load_dwordx4 v179, s[4:7], s86 offen offset:1024 lds
    s_waitcnt vmcnt(28)
    s_barrier
    s_mov_b32 s84, 768
    s_add_u32 m0, s83, 114688
    s_nop 0
    buffer_load_dwordx4 v200, s[20:23], s84 offen lds
    ds_read_b128 a[0:3], v180 offset:16384
    ds_read_b128 a[16:19], v188 offset:16384
    s_waitcnt lgkmcnt(2)
    v_mfma_f32_32x32x16_bf16 v[160:175], a[32:35], a[48:51], v[160:175]
    buffer_load_dwordx4 v201, s[20:23], s84 offen offset:1024 lds
    ds_read_b128 a[4:7], v181 offset:16384
    ds_read_b128 a[20:23], v189 offset:16384
    v_mfma_f32_32x32x16_bf16 v[160:175], a[36:39], a[52:55], v[160:175]
    s_mov_b32 s85, 1536
    s_add_u32 m0, s83, 122880
    s_nop 0
    buffer_load_dwordx4 v202, s[16:19], s85 offen lds
    ds_read_b128 a[8:11], v182 offset:16384
    ds_read_b128 a[24:27], v190 offset:16384
    v_mfma_f32_32x32x16_bf16 v[160:175], a[40:43], a[56:59], v[160:175]
    buffer_load_dwordx4 v203, s[16:19], s85 offen offset:1024 lds
    ds_read_b128 a[12:15], v183 offset:16384
    ds_read_b128 a[28:31], v191 offset:16384
    v_mfma_f32_32x32x16_bf16 v[160:175], a[44:47], a[60:63], v[160:175]
    s_waitcnt vmcnt(28)
    s_barrier
    s_mov_b32 s84, 768
    s_add_u32 m0, s83, 0
    s_nop 0
    buffer_load_dwordx4 v200, s[24:27], s84 offen lds
    ds_read_b128 a[32:35], v180 offset:32768
    ds_read_b128 a[48:51], v188 offset:32768
    s_waitcnt lgkmcnt(2)
    v_mfma_f32_32x32x16_bf16 v[160:175], a[0:3], a[16:19], v[160:175]
    buffer_load_dwordx4 v201, s[24:27], s84 offen offset:1024 lds
    ds_read_b128 a[36:39], v181 offset:32768
    ds_read_b128 a[52:55], v189 offset:32768
    v_mfma_f32_32x32x16_bf16 v[160:175], a[4:7], a[20:23], v[160:175]
    s_mov_b32 s85, 1600
    s_add_u32 m0, s83, 8192
    s_nop 0
    buffer_load_dwordx4 v202, s[16:19], s85 offen lds
    ds_read_b128 a[40:43], v182 offset:32768
    ds_read_b128 a[56:59], v190 offset:32768
    v_mfma_f32_32x32x16_bf16 v[160:175], a[8:11], a[24:27], v[160:175]
    buffer_load_dwordx4 v203, s[16:19], s85 offen offset:1024 lds
    ds_read_b128 a[44:47], v183 offset:32768
    ds_read_b128 a[60:63], v191 offset:32768
    v_mfma_f32_32x32x16_bf16 v[160:175], a[12:15], a[28:31], v[160:175]
    s_waitcnt vmcnt(28)
    s_barrier
    s_mov_b32 s84, 896
    s_add_u32 m0, s83, 16384
    s_nop 0
    buffer_load_dwordx4 v200, s[20:23], s84 offen lds
    ds_read_b128 a[0:3], v180 offset:49152
    ds_read_b128 a[16:19], v188 offset:49152
    s_waitcnt lgkmcnt(2)
    v_mfma_f32_32x32x16_bf16 v[160:175], a[32:35], a[48:51], v[160:175]
    buffer_load_dwordx4 v201, s[20:23], s84 offen offset:1024 lds
    ds_read_b128 a[4:7], v181 offset:49152
    ds_read_b128 a[20:23], v189 offset:49152
    v_mfma_f32_32x32x16_bf16 v[160:175], a[36:39], a[52:55], v[160:175]
    s_mov_b32 s85, 1792
    s_add_u32 m0, s83, 24576
    s_nop 0
    buffer_load_dwordx4 v202, s[16:19], s85 offen lds
    ds_read_b128 a[8:11], v182 offset:49152
    ds_read_b128 a[24:27], v190 offset:49152
    v_mfma_f32_32x32x16_bf16 v[160:175], a[40:43], a[56:59], v[160:175]
    buffer_load_dwordx4 v203, s[16:19], s85 offen offset:1024 lds
    ds_read_b128 a[12:15], v183 offset:49152
    ds_read_b128 a[28:31], v191 offset:49152
    v_mfma_f32_32x32x16_bf16 v[160:175], a[44:47], a[60:63], v[160:175]
    s_waitcnt vmcnt(28)
    s_barrier
    s_mov_b32 s84, 896
    s_add_u32 m0, s83, 32768
    s_nop 0
    buffer_load_dwordx4 v200, s[24:27], s84 offen lds
    ds_read_b128 a[32:35], v184 offset:0
    ds_read_b128 a[48:51], v192 offset:0
    s_waitcnt lgkmcnt(2)
    v_mfma_f32_32x32x16_bf16 v[160:175], a[0:3], a[16:19], v[160:175]
    buffer_load_dwordx4 v201, s[24:27], s84 offen offset:1024 lds
    ds_read_b128 a[36:39], v185 offset:0
    ds_read_b128 a[52:55], v193 offset:0
    v_mfma_f32_32x32x16_bf16 v[160:175], a[4:7], a[20:23], v[160:175]
    s_mov_b32 s85, 1856
    s_add_u32 m0, s83, 40960
    s_nop 0
    buffer_load_dwordx4 v202, s[16:19], s85 offen lds
    ds_read_b128 a[40:43], v186 offset:0
    ds_read_b128 a[56:59], v194 offset:0
    v_mfma_f32_32x32x16_bf16 v[160:175], a[8:11], a[24:27], v[160:175]
    buffer_load_dwordx4 v203, s[16:19], s85 offen offset:1024 lds
    ds_read_b128 a[44:47], v187 offset:0
    ds_read_b128 a[60:63], v195 offset:0
    v_mfma_f32_32x32x16_bf16 v[160:175], a[12:15], a[28:31], v[160:175]
    s_waitcnt vmcnt(28)
    s_barrier
    ds_read_b128 a[0:3], v184 offset:16384
    ds_read_b128 a[16:19], v192 offset:16384
    s_waitcnt lgkmcnt(2)
    v_mfma_f32_32x32x16_bf16 v[160:175], a[32:35], a[48:51], v[160:175]
    ds_read_b128 a[4:7], v185 offset:16384
    ds_read_b128 a[20:23], v193 offset:16384
    v_mfma_f32_32x32x16_bf16 v[160:175], a[36:39], a[52:55], v[160:175]
    s_mov_b32 s85, 0
    s_add_u32 m0, s83, 57344
    s_nop 0
    buffer_load_dwordx4 v206, s[28:31], s85 offen lds
    ds_read_b128 a[8:11], v186 offset:16384
    ds_read_b128 a[24:27], v194 offset:16384
    v_mfma_f32_32x32x16_bf16 v[160:175], a[40:43], a[56:59], v[160:175]
    buffer_load_dwordx4 v207, s[28:31], s85 offen offset:1024 lds
    ds_read_b128 a[12:15], v187 offset:16384
    ds_read_b128 a[28:31], v195 offset:16384
    v_mfma_f32_32x32x16_bf16 v[160:175], a[44:47], a[60:63], v[160:175]
    s_cmp_lg_u32 s3, 0
    s_cbranch_scc1 P3_NOFU
    buffer_load_dword v229, v228, s[16:19], s98 offen sc1
    P3_NOFU:
    s_waitcnt vmcnt(26)
    s_barrier
    ds_read_b128 a[32:35], v184 offset:32768
    ds_read_b128 a[48:51], v192 offset:32768
    s_waitcnt lgkmcnt(2)
    v_mfma_f32_32x32x16_bf16 v[160:175], a[0:3], a[16:19], v[160:175]
    ds_read_b128 a[36:39], v185 offset:32768
    ds_read_b128 a[52:55], v193 offset:32768
    v_mfma_f32_32x32x16_bf16 v[160:175], a[4:7], a[20:23], v[160:175]
    s_mov_b32 s85, 262144
    s_add_u32 m0, s83, 73728
    s_nop 0
    buffer_load_dwordx4 v206, s[28:31], s85 offen lds
    ds_read_b128 a[40:43], v186 offset:32768
    ds_read_b128 a[56:59], v194 offset:32768
    v_mfma_f32_32x32x16_bf16 v[160:175], a[8:11], a[24:27], v[160:175]
    buffer_load_dwordx4 v207, s[28:31], s85 offen offset:1024 lds
    ds_read_b128 a[44:47], v187 offset:32768
    ds_read_b128 a[60:63], v195 offset:32768
    v_mfma_f32_32x32x16_bf16 v[160:175], a[12:15], a[28:31], v[160:175]
    s_lshl_b32 s86, s3, 12
    s_add_u32 s86, s86, 131072
    v_and_b32 v100, 31, v1
    v_lshrrev_b32 v101, 5, v1
    v_lshlrev_b32 v101, 3, v101
    v_lshl_add_u32 v100, v100, 6, v101
    v_add_u32 v100, s86, v100
    s_waitcnt vmcnt(20)
    ds_read_b64 v[112:113], v100 offset:0
    ds_read_b64 v[114:115], v100 offset:16
    ds_read_b64 v[116:117], v100 offset:32
    ds_read_b64 v[118:119], v100 offset:48
    v_lshlrev_b32 v80, 16, v120
    v_and_b32 v81, 0xffff0000, v120
    v_lshlrev_b32 v82, 16, v121
    v_and_b32 v83, 0xffff0000, v121
    v_lshlrev_b32 v84, 16, v122
    v_and_b32 v85, 0xffff0000, v122
    v_lshlrev_b32 v86, 16, v123
    v_and_b32 v87, 0xffff0000, v123
    v_lshlrev_b32 v88, 16, v124
    v_and_b32 v89, 0xffff0000, v124
    v_lshlrev_b32 v90, 16, v125
    v_and_b32 v91, 0xffff0000, v125
    v_lshlrev_b32 v92, 16, v126
    v_and_b32 v93, 0xffff0000, v126
    v_lshlrev_b32 v94, 16, v127
    v_and_b32 v95, 0xffff0000, v127
    s_waitcnt lgkmcnt(0)
    v_lshlrev_b32 v64, 16, v112
    v_and_b32 v65, 0xffff0000, v112
    v_lshlrev_b32 v66, 16, v113
    v_and_b32 v67, 0xffff0000, v113
    v_lshlrev_b32 v68, 16, v114
    v_and_b32 v69, 0xffff0000, v114
    v_lshlrev_b32 v70, 16, v115
    v_and_b32 v71, 0xffff0000, v115
    v_lshlrev_b32 v72, 16, v116
    v_and_b32 v73, 0xffff0000, v116
    v_lshlrev_b32 v74, 16, v117
    v_and_b32 v75, 0xffff0000, v117
    v_lshlrev_b32 v76, 16, v118
    v_and_b32 v77, 0xffff0000, v118
    v_lshlrev_b32 v78, 16, v119
    v_and_b32 v79, 0xffff0000, v119
    v_lshlrev_b32 v102, 16, v225
    v_sub_f32 v104, 1.0, v224
    v_cvt_pk_bf16_f32 v100, v104, v104
    v_lshlrev_b32 v104, 16, v100
    v_pk_mul_f32 v[64:65], v[64:65], v[80:81]
    v_pk_mul_f32 v[66:67], v[66:67], v[82:83]
    v_pk_mul_f32 v[68:69], v[68:69], v[84:85]
    v_pk_mul_f32 v[70:71], v[70:71], v[86:87]
    v_pk_mul_f32 v[72:73], v[72:73], v[88:89]
    v_pk_mul_f32 v[74:75], v[74:75], v[90:91]
    v_pk_mul_f32 v[76:77], v[76:77], v[92:93]
    v_pk_mul_f32 v[78:79], v[78:79], v[94:95]
    v_cvt_pk_bf16_f32 v100, v64, v65
    v_lshlrev_b32 v64, 16, v100
    v_and_b32 v65, 0xffff0000, v100
    v_cvt_pk_bf16_f32 v100, v66, v67
    v_lshlrev_b32 v66, 16, v100
    v_and_b32 v67, 0xffff0000, v100
    v_cvt_pk_bf16_f32 v100, v68, v69
    v_lshlrev_b32 v68, 16, v100
    v_and_b32 v69, 0xffff0000, v100
    v_cvt_pk_bf16_f32 v100, v70, v71
    v_lshlrev_b32 v70, 16, v100
    v_and_b32 v71, 0xffff0000, v100
    v_cvt_pk_bf16_f32 v100, v72, v73
    v_lshlrev_b32 v72, 16, v100
    v_and_b32 v73, 0xffff0000, v100
    v_cvt_pk_bf16_f32 v100, v74, v75
    v_lshlrev_b32 v74, 16, v100
    v_and_b32 v75, 0xffff0000, v100
    v_cvt_pk_bf16_f32 v100, v76, v77
    v_lshlrev_b32 v76, 16, v100
    v_and_b32 v77, 0xffff0000, v100
    v_cvt_pk_bf16_f32 v100, v78, v79
    v_lshlrev_b32 v78, 16, v100
    v_and_b32 v79, 0xffff0000, v100
    s_waitcnt vmcnt(16)
    s_barrier
    s_cmp_lg_u32 s3, 0
    s_cbranch_scc1 P3_UOK
    s_waitcnt vmcnt(2)
P3_UCHK:
    v_cmp_ne_u32 vcc, v250, v229
    s_cbranch_vccz P3_UOK
    s_cmp_eq_u32 s96, 0
    s_cbranch_scc1 P3_UOK
    s_sub_u32 s96, s96, 1
    s_sleep 1
    buffer_load_dword v229, v228, s[16:19], s98 offen sc1
    s_waitcnt vmcnt(0)
    s_branch P3_UCHK
P3_UOK:
    s_barrier
    s_mov_b32 s84, 0
    s_add_u32 m0, s83, 49152
    s_nop 0
    buffer_load_dwordx4 v204, s[16:19], s84 offen lds
    buffer_load_dwordx4 v205, s[16:19], s84 offen offset:1024 lds
    s_mov_b32 s84, 128
    s_add_u32 m0, s83, 65536
    s_nop 0
    buffer_load_dwordx4 v204, s[16:19], s84 offen lds
    buffer_load_dwordx4 v205, s[16:19], s84 offen offset:1024 lds
    s_mov_b32 s84, 256
    s_add_u32 m0, s83, 81920
    s_nop 0
    buffer_load_dwordx4 v204, s[16:19], s84 offen lds
    ds_read_b128 a[0:3], v184 offset:49152
    ds_read_b128 a[16:19], v192 offset:49152
    s_waitcnt lgkmcnt(2)
    v_mfma_f32_32x32x16_bf16 v[160:175], a[32:35], a[48:51], v[160:175]
    buffer_load_dwordx4 v205, s[16:19], s84 offen offset:1024 lds
    ds_read_b128 a[4:7], v185 offset:49152
    ds_read_b128 a[20:23], v193 offset:49152
    v_mfma_f32_32x32x16_bf16 v[160:175], a[36:39], a[52:55], v[160:175]
    s_mov_b32 s85, 524288
    s_add_u32 m0, s83, 90112
    s_nop 0
    buffer_load_dwordx4 v206, s[28:31], s85 offen lds
    ds_read_b128 a[8:11], v186 offset:49152
    ds_read_b128 a[24:27], v194 offset:49152
    v_mfma_f32_32x32x16_bf16 v[160:175], a[40:43], a[56:59], v[160:175]
    buffer_load_dwordx4 v207, s[28:31], s85 offen offset:1024 lds
    ds_read_b128 a[12:15], v187 offset:49152
    ds_read_b128 a[28:31], v195 offset:49152
    v_mfma_f32_32x32x16_bf16 v[160:175], a[44:47], a[60:63], v[160:175]
    s_waitcnt vmcnt(20)
    s_barrier
    s_mov_b32 s84, 384
    s_add_u32 m0, s83, 98304
    s_nop 0
    buffer_load_dwordx4 v204, s[16:19], s84 offen lds
    ds_read_b128 a[32:35], v180 offset:0
    ds_read_b128 a[48:51], v188 offset:0
    s_waitcnt lgkmcnt(2)
    v_mfma_f32_32x32x16_bf16 v[160:175], a[0:3], a[16:19], v[160:175]
    buffer_load_dwordx4 v205, s[16:19], s84 offen offset:1024 lds
    ds_read_b128 a[36:39], v181 offset:0
    ds_read_b128 a[52:55], v189 offset:0
    v_mfma_f32_32x32x16_bf16 v[160:175], a[4:7], a[20:23], v[160:175]
    s_mov_b32 s85, 786432
    s_add_u32 m0, s83, 106496
    s_nop 0
    buffer_load_dwordx4 v206, s[28:31], s85 offen lds
    ds_read_b128 a[40:43], v182 offset:0
    ds_read_b128 a[56:59], v190 offset:0
    v_mfma_f32_32x32x16_bf16 v[160:175], a[8:11], a[24:27], v[160:175]
    buffer_load_dwordx4 v207, s[28:31], s85 offen offset:1024 lds
    ds_read_b128 a[44:47], v183 offset:0
    ds_read_b128 a[60:63], v191 offset:0
    v_mfma_f32_32x32x16_bf16 v[160:175], a[12:15], a[28:31], v[160:175]
    s_waitcnt vmcnt(20)
    s_barrier
    s_mov_b32 s84, 512
    s_add_u32 m0, s83, 114688
    s_nop 0
    buffer_load_dwordx4 v204, s[16:19], s84 offen lds
    ds_read_b128 a[0:3], v180 offset:16384
    ds_read_b128 a[16:19], v188 offset:16384
    s_waitcnt lgkmcnt(2)
    v_mfma_f32_32x32x16_bf16 v[160:175], a[32:35], a[48:51], v[160:175]
    buffer_load_dwordx4 v205, s[16:19], s84 offen offset:1024 lds
    ds_read_b128 a[4:7], v181 offset:16384
    ds_read_b128 a[20:23], v189 offset:16384
    v_mfma_f32_32x32x16_bf16 v[160:175], a[36:39], a[52:55], v[160:175]
    s_mov_b32 s85, 1048576
    s_add_u32 m0, s83, 122880
    s_nop 0
    buffer_load_dwordx4 v206, s[28:31], s85 offen lds
    ds_read_b128 a[8:11], v182 offset:16384
    ds_read_b128 a[24:27], v190 offset:16384
    v_mfma_f32_32x32x16_bf16 v[160:175], a[40:43], a[56:59], v[160:175]
    buffer_load_dwordx4 v207, s[28:31], s85 offen offset:1024 lds
    ds_read_b128 a[12:15], v183 offset:16384
    ds_read_b128 a[28:31], v191 offset:16384
    v_mfma_f32_32x32x16_bf16 v[160:175], a[44:47], a[60:63], v[160:175]
    s_waitcnt vmcnt(20)
    s_barrier
    s_mov_b32 s84, 640
    s_add_u32 m0, s83, 0
    s_nop 0
    buffer_load_dwordx4 v204, s[16:19], s84 offen lds
    ds_read_b128 a[32:35], v180 offset:32768
    ds_read_b128 a[48:51], v188 offset:32768
    s_waitcnt lgkmcnt(2)
    v_mfma_f32_32x32x16_bf16 v[160:175], a[0:3], a[16:19], v[160:175]
    buffer_load_dwordx4 v205, s[16:19], s84 offen offset:1024 lds
    ds_read_b128 a[36:39], v181 offset:32768
    ds_read_b128 a[52:55], v189 offset:32768
    v_mfma_f32_32x32x16_bf16 v[160:175], a[4:7], a[20:23], v[160:175]
    s_mov_b32 s85, 1310720
    s_add_u32 m0, s83, 8192
    s_nop 0
    buffer_load_dwordx4 v206, s[28:31], s85 offen lds
    ds_read_b128 a[40:43], v182 offset:32768
    ds_read_b128 a[56:59], v190 offset:32768
    v_mfma_f32_32x32x16_bf16 v[160:175], a[8:11], a[24:27], v[160:175]
    buffer_load_dwordx4 v207, s[28:31], s85 offen offset:1024 lds
    ds_read_b128 a[44:47], v183 offset:32768
    ds_read_b128 a[60:63], v191 offset:32768
    v_mfma_f32_32x32x16_bf16 v[160:175], a[12:15], a[28:31], v[160:175]
    s_waitcnt vmcnt(18)
    s_barrier
    s_mov_b32 s84, 768
    s_add_u32 m0, s83, 16384
    s_nop 0
    buffer_load_dwordx4 v204, s[16:19], s84 offen lds
    ds_read_b128 a[0:3], v180 offset:49152
    ds_read_b64_tr_b16 a[16:17], v196 offset:49152
    ds_read_b64_tr_b16 a[18:19], v196 offset:49664
    s_waitcnt lgkmcnt(3)
    v_mfma_f32_32x32x16_bf16 v[160:175], a[32:35], a[48:51], v[160:175]
    buffer_load_dwordx4 v205, s[16:19], s84 offen offset:1024 lds
    ds_read_b128 a[4:7], v181 offset:49152
    ds_read_b64_tr_b16 a[20:21], v196 offset:51200
    ds_read_b64_tr_b16 a[22:23], v196 offset:51712
    v_mfma_f32_32x32x16_bf16 v[160:175], a[36:39], a[52:55], v[160:175]
    s_mov_b32 s85, 1572864
    s_add_u32 m0, s83, 24576
    s_nop 0
    buffer_load_dwordx4 v206, s[28:31], s85 offen lds
    ds_read_b128 a[8:11], v182 offset:49152
    ds_read_b64_tr_b16 a[24:25], v196 offset:53248
    ds_read_b64_tr_b16 a[26:27], v196 offset:53760
    v_mfma_f32_32x32x16_bf16 v[160:175], a[40:43], a[56:59], v[160:175]
    buffer_load_dwordx4 v207, s[28:31], s85 offen offset:1024 lds
    ds_read_b128 a[12:15], v183 offset:49152
    ds_read_b64_tr_b16 a[28:29], v196 offset:55296
    ds_read_b64_tr_b16 a[30:31], v196 offset:55808
    v_mfma_f32_32x32x16_bf16 v[160:175], a[44:47], a[60:63], v[160:175]
    s_waitcnt vmcnt(20)
    s_barrier
    s_mov_b32 s84, 896
    s_add_u32 m0, s83, 32768
    s_nop 0
    buffer_load_dwordx4 v204, s[16:19], s84 offen lds
    ds_read_b128 a[32:35], v184 offset:0
    ds_read_b64_tr_b16 a[48:49], v197 offset:0
    ds_read_b64_tr_b16 a[50:51], v197 offset:512
    s_waitcnt lgkmcnt(3)
    v_mfma_f32_32x32x16_bf16 v[208:223], a[0:3], a[16:19], 0
    buffer_load_dwordx4 v205, s[16:19], s84 offen offset:1024 lds
    ds_read_b128 a[36:39], v185 offset:0
    ds_read_b64_tr_b16 a[52:53], v197 offset:2048
    ds_read_b64_tr_b16 a[54:55], v197 offset:2560
    v_mfma_f32_32x32x16_bf16 v[208:223], a[4:7], a[20:23], v[208:223]
    s_mov_b32 s85, 1835008
    s_add_u32 m0, s83, 40960
    s_nop 0
    buffer_load_dwordx4 v206, s[28:31], s85 offen lds
    ds_read_b128 a[40:43], v186 offset:0
    ds_read_b64_tr_b16 a[56:57], v197 offset:4096
    ds_read_b64_tr_b16 a[58:59], v197 offset:4608
    v_mfma_f32_32x32x16_bf16 v[208:223], a[8:11], a[24:27], v[208:223]
    buffer_load_dwordx4 v207, s[28:31], s85 offen offset:1024 lds
    ds_read_b128 a[44:47], v187 offset:0
    ds_read_b64_tr_b16 a[60:61], v197 offset:6144
    ds_read_b64_tr_b16 a[62:63], v197 offset:6656
    v_mfma_f32_32x32x16_bf16 v[208:223], a[12:15], a[28:31], v[208:223]
    s_waitcnt vmcnt(20)
    s_barrier
    s_mov_b32 s84, 1024
    s_add_u32 m0, s83, 49152
    s_nop 0
    buffer_load_dwordx4 v204, s[16:19], s84 offen lds
    ds_read_b128 a[0:3], v184 offset:16384
    ds_read_b64_tr_b16 a[16:17], v197 offset:16384
    ds_read_b64_tr_b16 a[18:19], v197 offset:16896
    s_waitcnt lgkmcnt(3)
    v_mfma_f32_32x32x16_bf16 v[208:223], a[32:35], a[48:51], v[208:223]
    buffer_load_dwordx4 v205, s[16:19], s84 offen offset:1024 lds
    ds_read_b128 a[4:7], v185 offset:16384
    ds_read_b64_tr_b16 a[20:21], v197 offset:18432
    ds_read_b64_tr_b16 a[22:23], v197 offset:18944
    v_mfma_f32_32x32x16_bf16 v[208:223], a[36:39], a[52:55], v[208:223]
    s_mov_b32 s85, 2097152
    s_add_u32 m0, s83, 57344
    s_nop 0
    buffer_load_dwordx4 v206, s[28:31], s85 offen lds
    ds_read_b128 a[8:11], v186 offset:16384
    ds_read_b64_tr_b16 a[24:25], v197 offset:20480
    ds_read_b64_tr_b16 a[26:27], v197 offset:20992
    v_mfma_f32_32x32x16_bf16 v[208:223], a[40:43], a[56:59], v[208:223]
    buffer_load_dwordx4 v207, s[28:31], s85 offen offset:1024 lds
    ds_read_b128 a[12:15], v187 offset:16384
    ds_read_b64_tr_b16 a[28:29], v197 offset:22528
    ds_read_b64_tr_b16 a[30:31], v197 offset:23040
    v_mfma_f32_32x32x16_bf16 v[208:223], a[44:47], a[60:63], v[208:223]
    v_pk_add_f32 v[160:161], v[160:161], v[64:65]
    v_pk_add_f32 v[162:163], v[162:163], v[66:67]
    v_pk_add_f32 v[164:165], v[164:165], v[68:69]
    v_pk_add_f32 v[166:167], v[166:167], v[70:71]
    v_pk_add_f32 v[168:169], v[168:169], v[72:73]
    v_pk_add_f32 v[170:171], v[170:171], v[74:75]
    v_pk_add_f32 v[172:173], v[172:173], v[76:77]
    v_pk_add_f32 v[174:175], v[174:175], v[78:79]
    v_pk_mul_f32 v[160:161], v[160:161], v[224:225] op_sel_hi:[1,0]
    v_pk_mul_f32 v[162:163], v[162:163], v[224:225] op_sel_hi:[1,0]
    v_pk_mul_f32 v[164:165], v[164:165], v[224:225] op_sel_hi:[1,0]
    v_pk_mul_f32 v[166:167], v[166:167], v[224:225] op_sel_hi:[1,0]
    v_pk_mul_f32 v[168:169], v[168:169], v[224:225] op_sel_hi:[1,0]
    v_pk_mul_f32 v[170:171], v[170:171], v[224:225] op_sel_hi:[1,0]
    v_pk_mul_f32 v[172:173], v[172:173], v[224:225] op_sel_hi:[1,0]
    v_pk_mul_f32 v[174:175], v[174:175], v[224:225] op_sel_hi:[1,0]
    s_waitcnt vmcnt(20)
    s_barrier
    s_mov_b32 s84, 1152
    s_add_u32 m0, s83, 65536
    s_nop 0
    buffer_load_dwordx4 v204, s[16:19], s84 offen lds
    ds_read_b128 a[32:35], v184 offset:32768
    ds_read_b64_tr_b16 a[48:49], v197 offset:32768
    ds_read_b64_tr_b16 a[50:51], v197 offset:33280
    s_waitcnt lgkmcnt(3)
    v_mfma_f32_32x32x16_bf16 v[208:223], a[0:3], a[16:19], v[208:223]
    buffer_load_dwordx4 v205, s[16:19], s84 offen offset:1024 lds
    ds_read_b128 a[36:39], v185 offset:32768
    ds_read_b64_tr_b16 a[52:53], v197 offset:34816
    ds_read_b64_tr_b16 a[54:55], v197 offset:35328
    v_mfma_f32_32x32x16_bf16 v[208:223], a[4:7], a[20:23], v[208:223]
    s_mov_b32 s85, 2359296
    s_add_u32 m0, s83, 73728
    s_nop 0
    buffer_load_dwordx4 v206, s[28:31], s85 offen lds
    ds_read_b128 a[40:43], v186 offset:32768
    ds_read_b64_tr_b16 a[56:57], v197 offset:36864
    ds_read_b64_tr_b16 a[58:59], v197 offset:37376
    v_mfma_f32_32x32x16_bf16 v[208:223], a[8:11], a[24:27], v[208:223]
    buffer_load_dwordx4 v207, s[28:31], s85 offen offset:1024 lds
    ds_read_b128 a[44:47], v187 offset:32768
    ds_read_b64_tr_b16 a[60:61], v197 offset:38912
    ds_read_b64_tr_b16 a[62:63], v197 offset:39424
    v_mfma_f32_32x32x16_bf16 v[208:223], a[12:15], a[28:31], v[208:223]
    s_lshl_b32 s86, s3, 12
    s_add_u32 s86, s86, 131072
    v_lshrrev_b32 v140, 5, v1
    v_and_b32 v141, 7, v1
    v_xor_b32 v140, v140, v141
    v_lshlrev_b32 v140, 4, v140
    v_and_b32 v136, 31, v1
    v_lshl_add_u32 v136, v136, 7, v140
    v_add_u32 v136, s86, v136
    v_xor_b32 v137, 32, v136
    v_xor_b32 v138, 64, v136
    v_xor_b32 v139, 96, v136
    v_lshrrev_b32 v140, 3, v1
    v_xor_b32 v141, v140, v141
    v_lshlrev_b32 v141, 4, v141
    v_lshl_add_u32 v140, v140, 7, v141
    v_add_u32 v140, s86, v140
    s_mov_b32 s87, 16384
    s_mov_b32 s88, 32768
    s_mov_b32 s89, 49152
    s_waitcnt vmcnt(20)
    s_barrier
    s_mov_b32 s84, 1280
    s_add_u32 m0, s83, 81920
    s_nop 0
    buffer_load_dwordx4 v204, s[16:19], s84 offen lds
    ds_read_b128 a[0:3], v184 offset:49152
    ds_read_b64_tr_b16 a[16:17], v197 offset:49152
    ds_read_b64_tr_b16 a[18:19], v197 offset:49664
    s_waitcnt lgkmcnt(3)
    v_mfma_f32_32x32x16_bf16 v[208:223], a[32:35], a[48:51], v[208:223]
    buffer_load_dwordx4 v205, s[16:19], s84 offen offset:1024 lds
    ds_read_b128 a[4:7], v185 offset:49152
    ds_read_b64_tr_b16 a[20:21], v197 offset:51200
    ds_read_b64_tr_b16 a[22:23], v197 offset:51712
    v_mfma_f32_32x32x16_bf16 v[208:223], a[36:39], a[52:55], v[208:223]
    s_mov_b32 s85, 2621440
    s_add_u32 m0, s83, 90112
    s_nop 0
    buffer_load_dwordx4 v206, s[28:31], s85 offen lds
    ds_read_b128 a[8:11], v186 offset:49152
    ds_read_b64_tr_b16 a[24:25], v197 offset:53248
    ds_read_b64_tr_b16 a[26:27], v197 offset:53760
    v_mfma_f32_32x32x16_bf16 v[208:223], a[40:43], a[56:59], v[208:223]
    buffer_load_dwordx4 v207, s[28:31], s85 offen offset:1024 lds
    ds_read_b128 a[12:15], v187 offset:49152
    ds_read_b64_tr_b16 a[28:29], v197 offset:55296
    ds_read_b64_tr_b16 a[30:31], v197 offset:55808
    v_mfma_f32_32x32x16_bf16 v[208:223], a[44:47], a[60:63], v[208:223]
    s_waitcnt vmcnt(20)
    s_barrier
    s_mov_b32 s84, 1408
    s_add_u32 m0, s83, 98304
    s_nop 0
    buffer_load_dwordx4 v204, s[16:19], s84 offen lds
    ds_read_b128 a[32:35], v180 offset:0
    ds_read_b64_tr_b16 a[48:49], v196 offset:0
    ds_read_b64_tr_b16 a[50:51], v196 offset:512
    s_waitcnt lgkmcnt(3)
    v_mfma_f32_32x32x16_bf16 v[208:223], a[0:3], a[16:19], v[208:223]
    buffer_load_dwordx4 v205, s[16:19], s84 offen offset:1024 lds
    ds_read_b128 a[36:39], v181 offset:0
    ds_read_b64_tr_b16 a[52:53], v196 offset:2048
    ds_read_b64_tr_b16 a[54:55], v196 offset:2560
    v_mfma_f32_32x32x16_bf16 v[208:223], a[4:7], a[20:23], v[208:223]
    s_mov_b32 s85, 2883584
    s_add_u32 m0, s83, 106496
    s_nop 0
    buffer_load_dwordx4 v206, s[28:31], s85 offen lds
    ds_read_b128 a[40:43], v182 offset:0
    ds_read_b64_tr_b16 a[56:57], v196 offset:4096
    ds_read_b64_tr_b16 a[58:59], v196 offset:4608
    v_mfma_f32_32x32x16_bf16 v[208:223], a[8:11], a[24:27], v[208:223]
    buffer_load_dwordx4 v207, s[28:31], s85 offen offset:1024 lds
    ds_read_b128 a[44:47], v183 offset:0
    ds_read_b64_tr_b16 a[60:61], v196 offset:6144
    ds_read_b64_tr_b16 a[62:63], v196 offset:6656
    v_mfma_f32_32x32x16_bf16 v[208:223], a[12:15], a[28:31], v[208:223]
    s_waitcnt vmcnt(20)
    s_barrier
    s_mov_b32 s84, 1536
    s_add_u32 m0, s83, 114688
    s_nop 0
    buffer_load_dwordx4 v204, s[16:19], s84 offen lds
    ds_read_b128 a[0:3], v180 offset:16384
    ds_read_b64_tr_b16 a[16:17], v196 offset:16384
    ds_read_b64_tr_b16 a[18:19], v196 offset:16896
    s_waitcnt lgkmcnt(3)
    v_mfma_f32_32x32x16_bf16 v[208:223], a[32:35], a[48:51], v[208:223]
    buffer_load_dwordx4 v205, s[16:19], s84 offen offset:1024 lds
    ds_read_b128 a[4:7], v181 offset:16384
    ds_read_b64_tr_b16 a[20:21], v196 offset:18432
    ds_read_b64_tr_b16 a[22:23], v196 offset:18944
    v_mfma_f32_32x32x16_bf16 v[208:223], a[36:39], a[52:55], v[208:223]
    s_mov_b32 s85, 3145728
    s_add_u32 m0, s83, 122880
    s_nop 0
    buffer_load_dwordx4 v206, s[28:31], s85 offen lds
    ds_read_b128 a[8:11], v182 offset:16384
    ds_read_b64_tr_b16 a[24:25], v196 offset:20480
    ds_read_b64_tr_b16 a[26:27], v196 offset:20992
    v_mfma_f32_32x32x16_bf16 v[208:223], a[40:43], a[56:59], v[208:223]
    buffer_load_dwordx4 v207, s[28:31], s85 offen offset:1024 lds
    ds_read_b128 a[12:15], v183 offset:16384
    ds_read_b64_tr_b16 a[28:29], v196 offset:22528
    ds_read_b64_tr_b16 a[30:31], v196 offset:23040
    v_mfma_f32_32x32x16_bf16 v[208:223], a[44:47], a[60:63], v[208:223]
    s_waitcnt vmcnt(20)
    s_barrier
    s_mov_b32 s84, 1664
    s_add_u32 m0, s83, 0
    s_nop 0
    buffer_load_dwordx4 v204, s[16:19], s84 offen lds
    ds_read_b128 a[32:35], v180 offset:32768
    ds_read_b64_tr_b16 a[48:49], v196 offset:32768
    ds_read_b64_tr_b16 a[50:51], v196 offset:33280
    s_waitcnt lgkmcnt(3)
    v_mfma_f32_32x32x16_bf16 v[208:223], a[0:3], a[16:19], v[208:223]
    buffer_load_dwordx4 v205, s[16:19], s84 offen offset:1024 lds
    ds_read_b128 a[36:39], v181 offset:32768
    ds_read_b64_tr_b16 a[52:53], v196 offset:34816
    ds_read_b64_tr_b16 a[54:55], v196 offset:35328
    v_mfma_f32_32x32x16_bf16 v[208:223], a[4:7], a[20:23], v[208:223]
    s_mov_b32 s85, 3407872
    s_add_u32 m0, s83, 8192
    s_nop 0
    buffer_load_dwordx4 v206, s[28:31], s85 offen lds
    ds_read_b128 a[40:43], v182 offset:32768
    ds_read_b64_tr_b16 a[56:57], v196 offset:36864
    ds_read_b64_tr_b16 a[58:59], v196 offset:37376
    v_mfma_f32_32x32x16_bf16 v[208:223], a[8:11], a[24:27], v[208:223]
    buffer_load_dwordx4 v207, s[28:31], s85 offen offset:1024 lds
    ds_read_b128 a[44:47], v183 offset:32768
    ds_read_b64_tr_b16 a[60:61], v196 offset:38912
    ds_read_b64_tr_b16 a[62:63], v196 offset:39424
    v_mfma_f32_32x32x16_bf16 v[208:223], a[12:15], a[28:31], v[208:223]
    s_waitcnt vmcnt(20)
    s_barrier
    s_mov_b32 s84, 1792
    s_add_u32 m0, s83, 16384
    s_nop 0
    buffer_load_dwordx4 v204, s[16:19], s84 offen lds
    ds_read_b128 a[0:3], v180 offset:49152
    ds_read_b64_tr_b16 a[16:17], v196 offset:49152
    ds_read_b64_tr_b16 a[18:19], v196 offset:49664
    s_waitcnt lgkmcnt(3)
    v_mfma_f32_32x32x16_bf16 v[208:223], a[32:35], a[48:51], v[208:223]
    buffer_load_dwordx4 v205, s[16:19], s84 offen offset:1024 lds
    ds_read_b128 a[4:7], v181 offset:49152
    ds_read_b64_tr_b16 a[20:21], v196 offset:51200
    ds_read_b64_tr_b16 a[22:23], v196 offset:51712
    v_mfma_f32_32x32x16_bf16 v[208:223], a[36:39], a[52:55], v[208:223]
    s_mov_b32 s85, 3670016
    s_add_u32 m0, s83, 24576
    s_nop 0
    buffer_load_dwordx4 v206, s[28:31], s85 offen lds
    ds_read_b128 a[8:11], v182 offset:49152
    ds_read_b64_tr_b16 a[24:25], v196 offset:53248
    ds_read_b64_tr_b16 a[26:27], v196 offset:53760
    v_mfma_f32_32x32x16_bf16 v[208:223], a[40:43], a[56:59], v[208:223]
    buffer_load_dwordx4 v207, s[28:31], s85 offen offset:1024 lds
    ds_read_b128 a[12:15], v183 offset:49152
    ds_read_b64_tr_b16 a[28:29], v196 offset:55296
    ds_read_b64_tr_b16 a[30:31], v196 offset:55808
    v_mfma_f32_32x32x16_bf16 v[208:223], a[44:47], a[60:63], v[208:223]
    s_waitcnt vmcnt(20)
    s_barrier
    s_mov_b32 s84, 1920
    s_add_u32 m0, s83, 32768
    s_nop 0
    buffer_load_dwordx4 v204, s[16:19], s84 offen lds
    ds_read_b128 a[32:35], v184 offset:0
    ds_read_b64_tr_b16 a[48:49], v197 offset:0
    ds_read_b64_tr_b16 a[50:51], v197 offset:512
    s_waitcnt lgkmcnt(3)
    v_mfma_f32_32x32x16_bf16 v[208:223], a[0:3], a[16:19], v[208:223]
    buffer_load_dwordx4 v205, s[16:19], s84 offen offset:1024 lds
    ds_read_b128 a[36:39], v185 offset:0
    ds_read_b64_tr_b16 a[52:53], v197 offset:2048
    ds_read_b64_tr_b16 a[54:55], v197 offset:2560
    v_mfma_f32_32x32x16_bf16 v[208:223], a[4:7], a[20:23], v[208:223]
    s_mov_b32 s85, 3932160
    s_add_u32 m0, s83, 40960
    s_nop 0
    buffer_load_dwordx4 v206, s[28:31], s85 offen lds
    ds_read_b128 a[40:43], v186 offset:0
    ds_read_b64_tr_b16 a[56:57], v197 offset:4096
    ds_read_b64_tr_b16 a[58:59], v197 offset:4608
    v_mfma_f32_32x32x16_bf16 v[208:223], a[8:11], a[24:27], v[208:223]
    buffer_load_dwordx4 v207, s[28:31], s85 offen offset:1024 lds
    ds_read_b128 a[44:47], v187 offset:0
    ds_read_b64_tr_b16 a[60:61], v197 offset:6144
    ds_read_b64_tr_b16 a[62:63], v197 offset:6656
    v_mfma_f32_32x32x16_bf16 v[208:223], a[12:15], a[28:31], v[208:223]
    s_waitcnt vmcnt(20)
    s_barrier
    s_mov_b32 s84, 2048
    s_add_u32 m0, s83, 49152
    s_nop 0
    buffer_load_dwordx4 v204, s[16:19], s84 offen lds
    ds_read_b128 a[0:3], v184 offset:16384
    ds_read_b64_tr_b16 a[16:17], v197 offset:16384
    ds_read_b64_tr_b16 a[18:19], v197 offset:16896
    s_waitcnt lgkmcnt(3)
    v_mfma_f32_32x32x16_bf16 v[208:223], a[32:35], a[48:51], v[208:223]
    buffer_load_dwordx4 v205, s[16:19], s84 offen offset:1024 lds
    ds_read_b128 a[4:7], v185 offset:16384
    ds_read_b64_tr_b16 a[20:21], v197 offset:18432
    ds_read_b64_tr_b16 a[22:23], v197 offset:18944
    v_mfma_f32_32x32x16_bf16 v[208:223], a[36:39], a[52:55], v[208:223]
    s_mov_b32 s85, 4194304
    s_add_u32 m0, s83, 57344
    s_nop 0
    buffer_load_dwordx4 v206, s[28:31], s85 offen lds
    ds_read_b128 a[8:11], v186 offset:16384
    ds_read_b64_tr_b16 a[24:25], v197 offset:20480
    ds_read_b64_tr_b16 a[26:27], v197 offset:20992
    v_mfma_f32_32x32x16_bf16 v[208:223], a[40:43], a[56:59], v[208:223]
    buffer_load_dwordx4 v207, s[28:31], s85 offen offset:1024 lds
    ds_read_b128 a[12:15], v187 offset:16384
    ds_read_b64_tr_b16 a[28:29], v197 offset:22528
    ds_read_b64_tr_b16 a[30:31], v197 offset:23040
    v_mfma_f32_32x32x16_bf16 v[208:223], a[44:47], a[60:63], v[208:223]
    s_waitcnt vmcnt(20)
    s_barrier
    s_mov_b32 s84, 2176
    s_add_u32 m0, s83, 65536
    s_nop 0
    buffer_load_dwordx4 v204, s[16:19], s84 offen lds
    ds_read_b128 a[32:35], v184 offset:32768
    ds_read_b64_tr_b16 a[48:49], v197 offset:32768
    ds_read_b64_tr_b16 a[50:51], v197 offset:33280
    s_waitcnt lgkmcnt(3)
    v_mfma_f32_32x32x16_bf16 v[208:223], a[0:3], a[16:19], v[208:223]
    buffer_load_dwordx4 v205, s[16:19], s84 offen offset:1024 lds
    ds_read_b128 a[36:39], v185 offset:32768
    ds_read_b64_tr_b16 a[52:53], v197 offset:34816
    ds_read_b64_tr_b16 a[54:55], v197 offset:35328
    v_mfma_f32_32x32x16_bf16 v[208:223], a[4:7], a[20:23], v[208:223]
    s_mov_b32 s85, 4456448
    s_add_u32 m0, s83, 73728
    s_nop 0
    buffer_load_dwordx4 v206, s[28:31], s85 offen lds
    ds_read_b128 a[40:43], v186 offset:32768
    ds_read_b64_tr_b16 a[56:57], v197 offset:36864
    ds_read_b64_tr_b16 a[58:59], v197 offset:37376
    v_mfma_f32_32x32x16_bf16 v[208:223], a[8:11], a[24:27], v[208:223]
    buffer_load_dwordx4 v207, s[28:31], s85 offen offset:1024 lds
    ds_read_b128 a[44:47], v187 offset:32768
    ds_read_b64_tr_b16 a[60:61], v197 offset:38912
    ds_read_b64_tr_b16 a[62:63], v197 offset:39424
    v_mfma_f32_32x32x16_bf16 v[208:223], a[12:15], a[28:31], v[208:223]
    s_waitcnt vmcnt(20)
    s_barrier
    s_mov_b32 s84, 2304
    s_add_u32 m0, s83, 81920
    s_nop 0
    buffer_load_dwordx4 v204, s[16:19], s84 offen lds
    ds_read_b128 a[0:3], v184 offset:49152
    ds_read_b64_tr_b16 a[16:17], v197 offset:49152
    ds_read_b64_tr_b16 a[18:19], v197 offset:49664
    s_waitcnt lgkmcnt(3)
    v_mfma_f32_32x32x16_bf16 v[208:223], a[32:35], a[48:51], v[208:223]
    buffer_load_dwordx4 v205, s[16:19], s84 offen offset:1024 lds
    ds_read_b128 a[4:7], v185 offset:49152
    ds_read_b64_tr_b16 a[20:21], v197 offset:51200
    ds_read_b64_tr_b16 a[22:23], v197 offset:51712
    v_mfma_f32_32x32x16_bf16 v[208:223], a[36:39], a[52:55], v[208:223]
    s_mov_b32 s85, 4718592
    s_add_u32 m0, s83, 90112
    s_nop 0
    buffer_load_dwordx4 v206, s[28:31], s85 offen lds
    ds_read_b128 a[8:11], v186 offset:49152
    ds_read_b64_tr_b16 a[24:25], v197 offset:53248
    ds_read_b64_tr_b16 a[26:27], v197 offset:53760
    v_mfma_f32_32x32x16_bf16 v[208:223], a[40:43], a[56:59], v[208:223]
    buffer_load_dwordx4 v207, s[28:31], s85 offen offset:1024 lds
    ds_read_b128 a[12:15], v187 offset:49152
    ds_read_b64_tr_b16 a[28:29], v197 offset:55296
    ds_read_b64_tr_b16 a[30:31], v197 offset:55808
    v_mfma_f32_32x32x16_bf16 v[208:223], a[44:47], a[60:63], v[208:223]
    s_waitcnt vmcnt(20)
    s_barrier
    s_mov_b32 s84, 2432
    s_add_u32 m0, s83, 98304
    s_nop 0
    buffer_load_dwordx4 v204, s[16:19], s84 offen lds
    ds_read_b128 a[32:35], v180 offset:0
    ds_read_b64_tr_b16 a[48:49], v196 offset:0
    ds_read_b64_tr_b16 a[50:51], v196 offset:512
    s_waitcnt lgkmcnt(3)
    v_mfma_f32_32x32x16_bf16 v[208:223], a[0:3], a[16:19], v[208:223]
    buffer_load_dwordx4 v205, s[16:19], s84 offen offset:1024 lds
    ds_read_b128 a[36:39], v181 offset:0
    ds_read_b64_tr_b16 a[52:53], v196 offset:2048
    ds_read_b64_tr_b16 a[54:55], v196 offset:2560
    v_mfma_f32_32x32x16_bf16 v[208:223], a[4:7], a[20:23], v[208:223]
    s_mov_b32 s85, 4980736
    s_add_u32 m0, s83, 106496
    s_nop 0
    buffer_load_dwordx4 v206, s[28:31], s85 offen lds
    ds_read_b128 a[40:43], v182 offset:0
    ds_read_b64_tr_b16 a[56:57], v196 offset:4096
    ds_read_b64_tr_b16 a[58:59], v196 offset:4608
    v_mfma_f32_32x32x16_bf16 v[208:223], a[8:11], a[24:27], v[208:223]
    buffer_load_dwordx4 v207, s[28:31], s85 offen offset:1024 lds
    ds_read_b128 a[44:47], v183 offset:0
    ds_read_b64_tr_b16 a[60:61], v196 offset:6144
    ds_read_b64_tr_b16 a[62:63], v196 offset:6656
    v_mfma_f32_32x32x16_bf16 v[208:223], a[12:15], a[28:31], v[208:223]
    s_waitcnt vmcnt(20)
    s_barrier
    s_mov_b32 s84, 2560
    s_add_u32 m0, s83, 114688
    s_nop 0
    buffer_load_dwordx4 v204, s[16:19], s84 offen lds
    ds_read_b128 a[0:3], v180 offset:16384
    ds_read_b64_tr_b16 a[16:17], v196 offset:16384
    ds_read_b64_tr_b16 a[18:19], v196 offset:16896
    s_waitcnt lgkmcnt(3)
    v_mfma_f32_32x32x16_bf16 v[208:223], a[32:35], a[48:51], v[208:223]
    buffer_load_dwordx4 v205, s[16:19], s84 offen offset:1024 lds
    ds_read_b128 a[4:7], v181 offset:16384
    ds_read_b64_tr_b16 a[20:21], v196 offset:18432
    ds_read_b64_tr_b16 a[22:23], v196 offset:18944
    v_mfma_f32_32x32x16_bf16 v[208:223], a[36:39], a[52:55], v[208:223]
    s_mov_b32 s85, 5242880
    s_add_u32 m0, s83, 122880
    s_nop 0
    buffer_load_dwordx4 v206, s[28:31], s85 offen lds
    ds_read_b128 a[8:11], v182 offset:16384
    ds_read_b64_tr_b16 a[24:25], v196 offset:20480
    ds_read_b64_tr_b16 a[26:27], v196 offset:20992
    v_mfma_f32_32x32x16_bf16 v[208:223], a[40:43], a[56:59], v[208:223]
    buffer_load_dwordx4 v207, s[28:31], s85 offen offset:1024 lds
    ds_read_b128 a[12:15], v183 offset:16384
    ds_read_b64_tr_b16 a[28:29], v196 offset:22528
    ds_read_b64_tr_b16 a[30:31], v196 offset:23040
    v_mfma_f32_32x32x16_bf16 v[208:223], a[44:47], a[60:63], v[208:223]
    s_waitcnt vmcnt(20)
    s_barrier
    s_mov_b32 s84, 2688
    s_add_u32 m0, s83, 0
    s_nop 0
    buffer_load_dwordx4 v204, s[16:19], s84 offen lds
    ds_read_b128 a[32:35], v180 offset:32768
    ds_read_b64_tr_b16 a[48:49], v196 offset:32768
    ds_read_b64_tr_b16 a[50:51], v196 offset:33280
    s_waitcnt lgkmcnt(3)
    v_mfma_f32_32x32x16_bf16 v[208:223], a[0:3], a[16:19], v[208:223]
    buffer_load_dwordx4 v205, s[16:19], s84 offen offset:1024 lds
    ds_read_b128 a[36:39], v181 offset:32768
    ds_read_b64_tr_b16 a[52:53], v196 offset:34816
    ds_read_b64_tr_b16 a[54:55], v196 offset:35328
    v_mfma_f32_32x32x16_bf16 v[208:223], a[4:7], a[20:23], v[208:223]
    s_mov_b32 s85, 5505024
    s_add_u32 m0, s83, 8192
    s_nop 0
    buffer_load_dwordx4 v206, s[28:31], s85 offen lds
    ds_read_b128 a[40:43], v182 offset:32768
    ds_read_b64_tr_b16 a[56:57], v196 offset:36864
    ds_read_b64_tr_b16 a[58:59], v196 offset:37376
    v_mfma_f32_32x32x16_bf16 v[208:223], a[8:11], a[24:27], v[208:223]
    buffer_load_dwordx4 v207, s[28:31], s85 offen offset:1024 lds
    ds_read_b128 a[44:47], v183 offset:32768
    ds_read_b64_tr_b16 a[60:61], v196 offset:38912
    ds_read_b64_tr_b16 a[62:63], v196 offset:39424
    v_mfma_f32_32x32x16_bf16 v[208:223], a[12:15], a[28:31], v[208:223]
    s_waitcnt vmcnt(20)
    s_barrier
    ds_read_b128 a[0:3], v180 offset:49152
    ds_read_b64_tr_b16 a[16:17], v196 offset:49152
    ds_read_b64_tr_b16 a[18:19], v196 offset:49664
    s_waitcnt lgkmcnt(3)
    v_mfma_f32_32x32x16_bf16 v[208:223], a[32:35], a[48:51], v[208:223]
    ds_read_b128 a[4:7], v181 offset:49152
    ds_read_b64_tr_b16 a[20:21], v196 offset:51200
    ds_read_b64_tr_b16 a[22:23], v196 offset:51712
    v_mfma_f32_32x32x16_bf16 v[208:223], a[36:39], a[52:55], v[208:223]
    ds_read_b128 a[8:11], v182 offset:49152
    ds_read_b64_tr_b16 a[24:25], v196 offset:53248
    ds_read_b64_tr_b16 a[26:27], v196 offset:53760
    v_mfma_f32_32x32x16_bf16 v[208:223], a[40:43], a[56:59], v[208:223]
    ds_read_b128 a[12:15], v183 offset:49152
    ds_read_b64_tr_b16 a[28:29], v196 offset:55296
    ds_read_b64_tr_b16 a[30:31], v196 offset:55808
    v_mfma_f32_32x32x16_bf16 v[208:223], a[44:47], a[60:63], v[208:223]
    s_waitcnt vmcnt(16)
    s_barrier
    ds_read_b128 a[32:35], v184 offset:0
    ds_read_b64_tr_b16 a[48:49], v197 offset:0
    ds_read_b64_tr_b16 a[50:51], v197 offset:512
    s_waitcnt lgkmcnt(3)
    v_mfma_f32_32x32x16_bf16 v[208:223], a[0:3], a[16:19], v[208:223]
    ds_read_b128 a[36:39], v185 offset:0
    ds_read_b64_tr_b16 a[52:53], v197 offset:2048
    ds_read_b64_tr_b16 a[54:55], v197 offset:2560
    v_mfma_f32_32x32x16_bf16 v[208:223], a[4:7], a[20:23], v[208:223]
    ds_read_b128 a[40:43], v186 offset:0
    ds_read_b64_tr_b16 a[56:57], v197 offset:4096
    ds_read_b64_tr_b16 a[58:59], v197 offset:4608
    v_mfma_f32_32x32x16_bf16 v[208:223], a[8:11], a[24:27], v[208:223]
    ds_read_b128 a[44:47], v187 offset:0
    ds_read_b64_tr_b16 a[60:61], v197 offset:6144
    ds_read_b64_tr_b16 a[62:63], v197 offset:6656
    v_mfma_f32_32x32x16_bf16 v[208:223], a[12:15], a[28:31], v[208:223]
    s_waitcnt vmcnt(12)
    s_barrier
    ds_read_b128 a[0:3], v184 offset:16384
    ds_read_b64_tr_b16 a[16:17], v197 offset:16384
    ds_read_b64_tr_b16 a[18:19], v197 offset:16896
    s_waitcnt lgkmcnt(3)
    v_mfma_f32_32x32x16_bf16 v[208:223], a[32:35], a[48:51], v[208:223]
    ds_read_b128 a[4:7], v185 offset:16384
    ds_read_b64_tr_b16 a[20:21], v197 offset:18432
    ds_read_b64_tr_b16 a[22:23], v197 offset:18944
    v_mfma_f32_32x32x16_bf16 v[208:223], a[36:39], a[52:55], v[208:223]
    ds_read_b128 a[8:11], v186 offset:16384
    ds_read_b64_tr_b16 a[24:25], v197 offset:20480
    ds_read_b64_tr_b16 a[26:27], v197 offset:20992
    v_mfma_f32_32x32x16_bf16 v[208:223], a[40:43], a[56:59], v[208:223]
    ds_read_b128 a[12:15], v187 offset:16384
    ds_read_b64_tr_b16 a[28:29], v197 offset:22528
    ds_read_b64_tr_b16 a[30:31], v197 offset:23040
    v_mfma_f32_32x32x16_bf16 v[208:223], a[44:47], a[60:63], v[208:223]
    s_waitcnt vmcnt(8)
    s_barrier
    ds_read_b128 a[32:35], v184 offset:32768
    ds_read_b64_tr_b16 a[48:49], v197 offset:32768
    ds_read_b64_tr_b16 a[50:51], v197 offset:33280
    s_waitcnt lgkmcnt(3)
    v_mfma_f32_32x32x16_bf16 v[208:223], a[0:3], a[16:19], v[208:223]
    ds_read_b128 a[36:39], v185 offset:32768
    ds_read_b64_tr_b16 a[52:53], v197 offset:34816
    ds_read_b64_tr_b16 a[54:55], v197 offset:35328
    v_mfma_f32_32x32x16_bf16 v[208:223], a[4:7], a[20:23], v[208:223]
    ds_read_b128 a[40:43], v186 offset:32768
    ds_read_b64_tr_b16 a[56:57], v197 offset:36864
    ds_read_b64_tr_b16 a[58:59], v197 offset:37376
    v_mfma_f32_32x32x16_bf16 v[208:223], a[8:11], a[24:27], v[208:223]
    ds_read_b128 a[44:47], v187 offset:32768
    ds_read_b64_tr_b16 a[60:61], v197 offset:38912
    ds_read_b64_tr_b16 a[62:63], v197 offset:39424
    v_mfma_f32_32x32x16_bf16 v[208:223], a[12:15], a[28:31], v[208:223]
    s_waitcnt vmcnt(4)
    s_barrier
    ds_read_b128 a[0:3], v184 offset:49152
    ds_read_b64_tr_b16 a[16:17], v197 offset:49152
    ds_read_b64_tr_b16 a[18:19], v197 offset:49664
    s_waitcnt lgkmcnt(3)
    v_mfma_f32_32x32x16_bf16 v[208:223], a[32:35], a[48:51], v[208:223]
    ds_read_b128 a[4:7], v185 offset:49152
    ds_read_b64_tr_b16 a[20:21], v197 offset:51200
    ds_read_b64_tr_b16 a[22:23], v197 offset:51712
    v_mfma_f32_32x32x16_bf16 v[208:223], a[36:39], a[52:55], v[208:223]
    ds_read_b128 a[8:11], v186 offset:49152
    ds_read_b64_tr_b16 a[24:25], v197 offset:53248
    ds_read_b64_tr_b16 a[26:27], v197 offset:53760
    v_mfma_f32_32x32x16_bf16 v[208:223], a[40:43], a[56:59], v[208:223]
    ds_read_b128 a[12:15], v187 offset:49152
    ds_read_b64_tr_b16 a[28:29], v197 offset:55296
    ds_read_b64_tr_b16 a[30:31], v197 offset:55808
    v_mfma_f32_32x32x16_bf16 v[208:223], a[44:47], a[60:63], v[208:223]
    s_waitcnt vmcnt(0)
    s_barrier
    ds_read_b128 a[32:35], v180 offset:0
    ds_read_b64_tr_b16 a[48:49], v196 offset:0
    ds_read_b64_tr_b16 a[50:51], v196 offset:512
    s_waitcnt lgkmcnt(3)
    v_mfma_f32_32x32x16_bf16 v[208:223], a[0:3], a[16:19], v[208:223]
    ds_read_b128 a[36:39], v181 offset:0
    ds_read_b64_tr_b16 a[52:53], v196 offset:2048
    ds_read_b64_tr_b16 a[54:55], v196 offset:2560
    v_mfma_f32_32x32x16_bf16 v[208:223], a[4:7], a[20:23], v[208:223]
    ds_read_b128 a[40:43], v182 offset:0
    ds_read_b64_tr_b16 a[56:57], v196 offset:4096
    ds_read_b64_tr_b16 a[58:59], v196 offset:4608
    v_mfma_f32_32x32x16_bf16 v[208:223], a[8:11], a[24:27], v[208:223]
    ds_read_b128 a[44:47], v183 offset:0
    ds_read_b64_tr_b16 a[60:61], v196 offset:6144
    ds_read_b64_tr_b16 a[62:63], v196 offset:6656
    v_mfma_f32_32x32x16_bf16 v[208:223], a[12:15], a[28:31], v[208:223]
    s_waitcnt lgkmcnt(0)
    v_mfma_f32_32x32x16_bf16 v[208:223], a[32:35], a[48:51], v[208:223]
    v_mfma_f32_32x32x16_bf16 v[208:223], a[36:39], a[52:55], v[208:223]
    v_mfma_f32_32x32x16_bf16 v[208:223], a[40:43], a[56:59], v[208:223]
    v_mfma_f32_32x32x16_bf16 v[208:223], a[44:47], a[60:63], v[208:223]
    s_nop 12
    v_cvt_pk_bf16_f32 v100, v208, v209
    v_lshlrev_b32 v208, 16, v100
    v_and_b32 v209, 0xffff0000, v100
    v_cvt_pk_bf16_f32 v100, v210, v211
    v_lshlrev_b32 v210, 16, v100
    v_and_b32 v211, 0xffff0000, v100
    v_pk_add_f32 v[208:209], v[208:209], v[102:103] op_sel_hi:[1,0]
    v_pk_add_f32 v[210:211], v[210:211], v[102:103] op_sel_hi:[1,0]
    v_cvt_pk_bf16_f32 v100, v208, v209
    v_lshlrev_b32 v208, 16, v100
    v_and_b32 v209, 0xffff0000, v100
    v_cvt_pk_bf16_f32 v100, v210, v211
    v_lshlrev_b32 v210, 16, v100
    v_and_b32 v211, 0xffff0000, v100
    v_pk_mul_f32 v[208:209], v[208:209], v[104:105] op_sel_hi:[1,0]
    v_pk_mul_f32 v[210:211], v[210:211], v[104:105] op_sel_hi:[1,0]
    v_cvt_pk_bf16_f32 v100, v208, v209
    v_lshlrev_b32 v208, 16, v100
    v_and_b32 v209, 0xffff0000, v100
    v_cvt_pk_bf16_f32 v100, v210, v211
    v_lshlrev_b32 v210, 16, v100
    v_and_b32 v211, 0xffff0000, v100
    v_pk_add_f32 v[208:209], v[208:209], v[160:161]
    v_pk_add_f32 v[210:211], v[210:211], v[162:163]
    ds_write_b128 v136, v[208:211]
    v_cvt_pk_bf16_f32 v100, v212, v213
    v_lshlrev_b32 v212, 16, v100
    v_and_b32 v213, 0xffff0000, v100
    v_cvt_pk_bf16_f32 v100, v214, v215
    v_lshlrev_b32 v214, 16, v100
    v_and_b32 v215, 0xffff0000, v100
    v_pk_add_f32 v[212:213], v[212:213], v[102:103] op_sel_hi:[1,0]
    v_pk_add_f32 v[214:215], v[214:215], v[102:103] op_sel_hi:[1,0]
    v_cvt_pk_bf16_f32 v100, v212, v213
    v_lshlrev_b32 v212, 16, v100
    v_and_b32 v213, 0xffff0000, v100
    v_cvt_pk_bf16_f32 v100, v214, v215
    v_lshlrev_b32 v214, 16, v100
    v_and_b32 v215, 0xffff0000, v100
    v_pk_mul_f32 v[212:213], v[212:213], v[104:105] op_sel_hi:[1,0]
    v_pk_mul_f32 v[214:215], v[214:215], v[104:105] op_sel_hi:[1,0]
    v_cvt_pk_bf16_f32 v100, v212, v213
    v_lshlrev_b32 v212, 16, v100
    v_and_b32 v213, 0xffff0000, v100
    v_cvt_pk_bf16_f32 v100, v214, v215
    v_lshlrev_b32 v214, 16, v100
    v_and_b32 v215, 0xffff0000, v100
    v_pk_add_f32 v[212:213], v[212:213], v[164:165]
    v_pk_add_f32 v[214:215], v[214:215], v[166:167]
    ds_write_b128 v137, v[212:215]
    v_cvt_pk_bf16_f32 v100, v216, v217
    v_lshlrev_b32 v216, 16, v100
    v_and_b32 v217, 0xffff0000, v100
    v_cvt_pk_bf16_f32 v100, v218, v219
    v_lshlrev_b32 v218, 16, v100
    v_and_b32 v219, 0xffff0000, v100
    v_pk_add_f32 v[216:217], v[216:217], v[102:103] op_sel_hi:[1,0]
    v_pk_add_f32 v[218:219], v[218:219], v[102:103] op_sel_hi:[1,0]
    v_cvt_pk_bf16_f32 v100, v216, v217
    v_lshlrev_b32 v216, 16, v100
    v_and_b32 v217, 0xffff0000, v100
    v_cvt_pk_bf16_f32 v100, v218, v219
    v_lshlrev_b32 v218, 16, v100
    v_and_b32 v219, 0xffff0000, v100
    v_pk_mul_f32 v[216:217], v[216:217], v[104:105] op_sel_hi:[1,0]
    v_pk_mul_f32 v[218:219], v[218:219], v[104:105] op_sel_hi:[1,0]
    v_cvt_pk_bf16_f32 v100, v216, v217
    v_lshlrev_b32 v216, 16, v100
    v_and_b32 v217, 0xffff0000, v100
    v_cvt_pk_bf16_f32 v100, v218, v219
    v_lshlrev_b32 v218, 16, v100
    v_and_b32 v219, 0xffff0000, v100
    v_pk_add_f32 v[216:217], v[216:217], v[168:169]
    v_pk_add_f32 v[218:219], v[218:219], v[170:171]
    ds_write_b128 v138, v[216:219]
    v_cvt_pk_bf16_f32 v100, v220, v221
    v_lshlrev_b32 v220, 16, v100
    v_and_b32 v221, 0xffff0000, v100
    v_cvt_pk_bf16_f32 v100, v222, v223
    v_lshlrev_b32 v222, 16, v100
    v_and_b32 v223, 0xffff0000, v100
    v_pk_add_f32 v[220:221], v[220:221], v[102:103] op_sel_hi:[1,0]
    v_pk_add_f32 v[222:223], v[222:223], v[102:103] op_sel_hi:[1,0]
    v_cvt_pk_bf16_f32 v100, v220, v221
    v_lshlrev_b32 v220, 16, v100
    v_and_b32 v221, 0xffff0000, v100
    v_cvt_pk_bf16_f32 v100, v222, v223
    v_lshlrev_b32 v222, 16, v100
    v_and_b32 v223, 0xffff0000, v100
    v_pk_mul_f32 v[220:221], v[220:221], v[104:105] op_sel_hi:[1,0]
    v_pk_mul_f32 v[222:223], v[222:223], v[104:105] op_sel_hi:[1,0]
    v_cvt_pk_bf16_f32 v100, v220, v221
    v_lshlrev_b32 v220, 16, v100
    v_and_b32 v221, 0xffff0000, v100
    v_cvt_pk_bf16_f32 v100, v222, v223
    v_lshlrev_b32 v222, 16, v100
    v_and_b32 v223, 0xffff0000, v100
    v_pk_add_f32 v[220:221], v[220:221], v[172:173]
    v_pk_add_f32 v[222:223], v[222:223], v[174:175]
    ds_write_b128 v139, v[220:223]
    s_waitcnt lgkmcnt(0)
    ds_read_b128 v[208:211], v140 offset:0
    ds_read_b128 v[212:215], v140 offset:1024
    ds_read_b128 v[216:219], v140 offset:2048
    ds_read_b128 v[220:223], v140 offset:3072
    s_waitcnt lgkmcnt(3)
    buffer_store_dwordx4 v[208:211], v198, s[32:35], 0 offen sc0 sc1
    s_waitcnt lgkmcnt(2)
    buffer_store_dwordx4 v[212:215], v198, s[32:35], s87 offen sc0 sc1
    s_waitcnt lgkmcnt(1)
    buffer_store_dwordx4 v[216:219], v198, s[32:35], s88 offen sc0 sc1
    s_waitcnt lgkmcnt(0)
    buffer_store_dwordx4 v[220:223], v198, s[32:35], s89 offen sc0 sc1
K_END:
    s_endpgm
.section .rodata,"a"
.p2align 6
.amdhsa_kernel gated_mix__ssm_conv_s5__mixer_token_mlp__prompt_kernel
  .amdhsa_next_free_vgpr 368
  .amdhsa_next_free_sgpr 102
  .amdhsa_accum_offset 256
  .amdhsa_group_segment_fixed_size 0
  .amdhsa_kernarg_size 144
  .amdhsa_user_sgpr_count 2
  .amdhsa_user_sgpr_kernarg_segment_ptr 1
  .amdhsa_system_sgpr_workgroup_id_x 1
.end_amdhsa_kernel
```
